```python
import torch

def _softmax(x, axis=-1):
    return torch.softmax(x, dim=axis)
def _gelu(x):
    return torch.nn.functional.gelu(x, approximate="tanh")
def _silu(x):
    return torch.nn.functional.silu(x)
def _sigmoid(x):
    return torch.sigmoid(x)
def _layernorm(x, axis=-1, eps=1e-5):
    m = x.mean(dim=axis, keepdim=True)
    v = x.var(dim=axis, keepdim=True, unbiased=False)
    return (x - m) / torch.sqrt(v + eps)
def _scatter_add(tgt, idx, src, axis=0):
    return tgt.clone().index_add_(axis, idx, src)
def _segment_sum(src, seg, n):
    out = torch.zeros((n,) + src.shape[1:], dtype=src.dtype)
    return out.index_add_(0, seg, src)
def _pad(x, pw):
    flat = tuple(v for pair in reversed(pw) for v in pair)
    return torch.nn.functional.pad(x, flat)

kernel_name = 'gated_mix__mha_block_cached__swiglu_ffn__decode'

def setup_inputs():

    _w = (lambda a: (lambda t: t.to(torch.bfloat16) if t.is_floating_point() else t)(torch.as_tensor(a)))
    def _A_setup():
        B, Sq, D = 8, 1, 448
        H, Sk, Dh = 16, 4096, 256
        return {
            "x": _w((lambda *s: torch.randn(*s, dtype=torch.bfloat16) * 0.05)(B, Sq, D)),
            "k_cache": _w((lambda *s: torch.randn(*s, dtype=torch.bfloat16) * 6.4)(B, H, Sk, Dh)),
            "v_cache": _w((lambda *s: torch.randn(*s, dtype=torch.bfloat16) * 0.2)(B, H, Sk, Dh)),
            "wq": _w((lambda *s: torch.randn(*s, dtype=torch.bfloat16) * 6.4)(D, H * Dh) * (D ** -0.5)),
            "wo": _w((lambda *s: torch.randn(*s, dtype=torch.bfloat16) * 0.2)(H * Dh, D) * ((H * Dh) ** -0.5)),
        }
    _A_in = _A_setup()

    def _B_setup():
        B, S, D, F = 8, 1, 448, 1792
        return {
            "x": _w((lambda *s: torch.randn(*s, dtype=torch.bfloat16) * 0.05)(B, S, D)),
            "w_gate": _w((lambda *s: torch.randn(*s, dtype=torch.bfloat16) * 0.05)(D, F)),
            "w_up": _w((lambda *s: torch.randn(*s, dtype=torch.bfloat16) * 0.05)(D, F)),
            "w_down": _w((lambda *s: torch.randn(*s, dtype=torch.bfloat16) * 0.05)(F, D)),
        }
    _B_in = _B_setup()

    return {
        "A_x": _A_in["x"],
        "A_k_cache": _A_in["k_cache"],
        "A_v_cache": _A_in["v_cache"],
        "A_wq": _A_in["wq"],
        "A_wo": _A_in["wo"],
        "B_x": _B_in["x"],
        "B_w_gate": _B_in["w_gate"],
        "B_w_up": _B_in["w_up"],
        "B_w_down": _B_in["w_down"],
        "gate_w": _w((lambda *s: torch.randn(*s, dtype=torch.bfloat16) * 0.05)(448) * 16.0),
    }

def reference(A_x, A_k_cache, A_v_cache, A_wq, A_wo, B_x, B_w_gate, B_w_up, B_w_down, gate_w):
    def _A_ref(x, k_cache, v_cache, wq, wo):
        B, Sq, D = x.shape
        H, Dh = 16, 256
        q = (lambda x, *d: x.permute(*d))((x @ wq).reshape(B, Sq, H, Dh), 0, 2, 1, 3)
        scores = torch.einsum("bhqd,bhkd->bhqk", q, k_cache) * (Dh ** -0.5)
        p = _softmax(scores, axis=-1)
        o = torch.einsum("bhqk,bhkd->bhqd", p, v_cache)
        return (lambda x, *d: x.permute(*d))(o, 0, 2, 1, 3).reshape(B, Sq, H * Dh) @ wo

    def _B_ref(x, w_gate, w_up, w_down):
        g = _silu(x @ w_gate)
        u = x @ w_up
        return (g * u) @ w_down

    x = A_x
    g = _sigmoid((x * gate_w).sum(-1, keepdims=True))
    a = _A_ref(x, A_k_cache, A_v_cache, A_wq, A_wo)
    b = _B_ref(x, B_w_gate, B_w_up, B_w_down)
    return g * a + (1 - g) * b
```

```asm
; @launch grid=(256,1,1) block=(512,1,1) lds=155648
.amdgcn_target "amdgcn-amd-amdhsa--gfx950"
.text
.globl gated_mix__mha_block_cached__swiglu_ffn__decode_kernel
.p2align 8
.type gated_mix__mha_block_cached__swiglu_ffn__decode_kernel,@function
gated_mix__mha_block_cached__swiglu_ffn__decode_kernel:
  s_cmp_ge_u32 s2, 256
  s_cbranch_scc1 L_end
  s_load_dwordx16 s[4:19], s[0:1], 0
  s_load_dwordx8 s[20:27], s[0:1], 64
  s_load_dwordx2 s[28:29], s[0:1], 96
  v_lshrrev_b32 v1, 6, v0
  v_and_b32 v0, 63, v0
  v_readfirstlane_b32 s3, v1
  v_lshrrev_b32 v2, 4, v0
  v_and_b32 v3, 15, v0
  s_and_b32 s30, s2, 7
  s_lshr_b32 s31, s2, 3
  s_and_b32 s32, s31, 7
  s_bfe_u32 s33, s31, 0x10003
  s_lshl_b32 s35, s30, 5
  s_add_u32 s35, s35, s31
  s_lshr_b32 s36, s31, 4
  s_lshl1_add_u32 s34, s30, s36
  s_lshl3_add_u32 s62, s36, s30
  s_sub_u32 s36, 7, s32
  s_lshl4_add_u32 s62, s36, s62
  s_lshr_b32 s36, s34, 3
  s_lshl1_add_u32 s36, s36, s33
  s_and_b32 s37, s34, 7
  s_lshl3_add_u32 s39, s36, s37
  s_mul_i32 s72, s32, 10240
  s_lshl_b32 s36, s39, 8
  s_add_u32 s72, s72, s36
  s_add_u32 s72, s72, 327680
  s_sub_u32 s38, s3, 2
  s_cmp_lt_u32 s38, 4
  s_cbranch_scc1 L_stream
  s_setprio 3
  v_lshlrev_b32 v6, 4, v0
  v_and_b32 v11, 7, v3
  v_mov_b32 v14, 0
  s_cmp_eq_u32 s3, 1
  s_cbranch_scc1 L_j
  s_cmp_lg_u32 s3, 0
  s_cbranch_scc1 L_w
  s_memrealtime s[68:69]
  v_lshrrev_b32 v4, 2, v0
  v_lshlrev_b32 v4, 13, v4
  v_and_b32 v5, 3, v0
  v_lshl_add_u32 v4, v5, 4, v4
  v_mul_u32_u24 v5, 896, v11
  v_lshrrev_b32 v7, 3, v3
  v_lshl_add_u32 v5, v7, 6, v5
  v_lshl_add_u32 v5, v2, 4, v5
  s_lshl_b32 s36, s35, 5
  s_andn2_b32 s36, s36, 63
  s_and_b32 s30, s35, 1
  s_mul_i32 s30, s30, 1835008
  s_add_u32 s36, s36, s30
  s_sub_u32 s30, 448*8192, s36
  s_mov_b32 s44, 0
  v_lshlrev_b32 v9, 3, v0
  s_waitcnt lgkmcnt(0)
  s_load_dword s60, s[28:29], 0
  s_mov_b32 s56, s4
  s_and_b32 s57, s5, 0xffff
  s_mov_b32 s58, 7168
  s_mov_b32 s59, 0x20000
  s_and_b32 s45, s35, 1
  s_mul_i32 s46, s45, 448
  buffer_load_dwordx4 v[88:91], v5, s[56:59], s46 offen offset:0
  buffer_load_dwordx4 v[92:95], v5, s[56:59], s46 offen offset:128
  buffer_load_dwordx4 v[96:99], v5, s[56:59], s46 offen offset:256
  buffer_load_dwordx4 v[100:103], v5, s[56:59], s46 offen offset:384
  s_add_u32 s48, s10, s36
  s_addc_u32 s49, s11, 0
  s_and_b32 s49, s49, 0xffff
  s_mov_b32 s50, s30
  s_mov_b32 s51, 0x20000
  buffer_load_dwordx4 v[32:35], v4, s[48:51], s44 offen nt
  s_add_u32 s44, s44, 131072
  buffer_load_dwordx4 v[36:39], v4, s[48:51], s44 offen nt
  s_add_u32 s44, s44, 131072
  buffer_load_dwordx4 v[40:43], v4, s[48:51], s44 offen nt
  s_add_u32 s44, s44, 131072
  buffer_load_dwordx4 v[44:47], v4, s[48:51], s44 offen nt
  s_add_u32 s44, s44, 131072
  buffer_load_dwordx4 v[48:51], v4, s[48:51], s44 offen nt
  s_add_u32 s44, s44, 131072
  buffer_load_dwordx4 v[52:55], v4, s[48:51], s44 offen nt
  s_add_u32 s44, s44, 131072
  buffer_load_dwordx4 v[56:59], v4, s[48:51], s44 offen nt
  s_add_u32 s44, s44, 131072
  buffer_load_dwordx4 v[60:63], v4, s[48:51], s44 offen nt
  s_add_u32 s44, s44, 131072
  buffer_load_dwordx4 v[64:67], v4, s[48:51], s44 offen nt
  s_add_u32 s44, s44, 131072
  buffer_load_dwordx4 v[68:71], v4, s[48:51], s44 offen nt
  s_add_u32 s44, s44, 131072
  buffer_load_dwordx4 v[72:75], v4, s[48:51], s44 offen nt
  s_add_u32 s44, s44, 131072
  buffer_load_dwordx4 v[76:79], v4, s[48:51], s44 offen nt
  s_add_u32 s44, s44, 131072
  buffer_load_dwordx4 v[80:83], v4, s[48:51], s44 offen nt
  s_add_u32 s44, s44, 131072
  buffer_load_dwordx4 v[84:87], v4, s[48:51], s44 offen nt
  s_barrier
  s_mov_b32 s40, s28
  s_and_b32 s41, s29, 0xffff
  s_mov_b32 s42, 1048576
  s_mov_b32 s43, 0x20000
  v_mul_u32_u24 v7, 544, v2
  v_lshrrev_b32 v8, 2, v3
  v_lshl_add_u32 v7, v8, 6, v7
  v_and_b32 v8, 3, v3
  v_lshl_add_u32 v7, v8, 3, v7
  v_lshlrev_b32 v8, 11, v11
  v_lshrrev_b32 v10, 3, v3
  v_lshl_add_u32 v8, v10, 6, v8
  v_lshl_add_u32 v8, v2, 4, v8
  v_lshrrev_b32 v10, 5, v0
  v_lshl_add_u32 v10, v10, 5, v6
  s_lshl3_add_u32 s46, s34, s32
  s_lshl_b32 s46, s46, 11
  s_add_u32 s46, s46, 65536
  s_lshl_b32 s45, s45, 10
  s_lshr_b32 s36, s35, 4
  s_lshl_b32 s36, s36, 14
  s_add_u32 s45, s45, s36
  s_bfe_u32 s36, s35, 0x30001
  s_lshl_b32 s36, s36, 7
  s_add_u32 s45, s45, s36
  s_add_u32 s45, s45, 65536
  s_movk_i32 s73, 0x3f
  s_waitcnt lgkmcnt(0)
  s_add_u32 s60, s60, 1
  v_mov_b32 v25, s60
  v_mov_b32 v27, s60
  ds_write_b32 v14, v25 offset:544
  v_mov_b32 v12, s60
  s_waitcnt vmcnt(12)
  ds_write_b128 v10, v[32:35] offset:16384
  ds_write_b128 v10, v[36:39] offset:17472
  ds_read_b64_tr_b16 v[144:145], v7 offset:16384
  ds_read_b64_tr_b16 v[146:147], v7 offset:16640
  ds_read_b64_tr_b16 v[148:149], v7 offset:16416
  ds_read_b64_tr_b16 v[150:151], v7 offset:16672
  s_waitcnt vmcnt(10)
  ds_write_b128 v10, v[40:43] offset:18560
  ds_write_b128 v10, v[44:47] offset:19648
  ds_read_b64_tr_b16 v[152:153], v7 offset:18560
  ds_read_b64_tr_b16 v[154:155], v7 offset:18816
  ds_read_b64_tr_b16 v[156:157], v7 offset:18592
  ds_read_b64_tr_b16 v[158:159], v7 offset:18848
  s_waitcnt lgkmcnt(6)
  v_mfma_f32_16x16x32_bf16 v[16:19], v[144:147], v[88:91], 0
  v_mfma_f32_16x16x32_bf16 v[24:27], v[148:151], v[88:91], 0
  s_waitcnt vmcnt(8)
  ds_write_b128 v10, v[48:51] offset:20736
  ds_write_b128 v10, v[52:55] offset:21824
  ds_read_b64_tr_b16 v[160:161], v7 offset:20736
  ds_read_b64_tr_b16 v[162:163], v7 offset:20992
  ds_read_b64_tr_b16 v[164:165], v7 offset:20768
  ds_read_b64_tr_b16 v[166:167], v7 offset:21024
  s_waitcnt lgkmcnt(6)
  v_mfma_f32_16x16x32_bf16 v[20:23], v[152:155], v[88:91], 0
  v_mfma_f32_16x16x32_bf16 v[28:31], v[156:159], v[88:91], 0
  s_waitcnt vmcnt(6)
  ds_write_b128 v10, v[56:59] offset:22912
  ds_write_b128 v10, v[60:63] offset:24000
  ds_read_b64_tr_b16 v[168:169], v7 offset:22912
  ds_read_b64_tr_b16 v[170:171], v7 offset:23168
  ds_read_b64_tr_b16 v[172:173], v7 offset:22944
  ds_read_b64_tr_b16 v[174:175], v7 offset:23200
  s_waitcnt lgkmcnt(6)
  v_mfma_f32_16x16x32_bf16 v[16:19], v[160:163], v[92:95], v[16:19]
  v_mfma_f32_16x16x32_bf16 v[24:27], v[164:167], v[92:95], v[24:27]
  s_waitcnt vmcnt(4)
  ds_write_b128 v10, v[64:67] offset:25088
  ds_write_b128 v10, v[68:71] offset:26176
  ds_read_b64_tr_b16 v[176:177], v7 offset:25088
  ds_read_b64_tr_b16 v[178:179], v7 offset:25344
  ds_read_b64_tr_b16 v[180:181], v7 offset:25120
  ds_read_b64_tr_b16 v[182:183], v7 offset:25376
  s_waitcnt lgkmcnt(6)
  v_mfma_f32_16x16x32_bf16 v[20:23], v[168:171], v[92:95], v[20:23]
  v_mfma_f32_16x16x32_bf16 v[28:31], v[172:175], v[92:95], v[28:31]
  s_waitcnt vmcnt(2)
  ds_write_b128 v10, v[72:75] offset:27264
  ds_write_b128 v10, v[76:79] offset:28352
  ds_read_b64_tr_b16 v[184:185], v7 offset:27264
  ds_read_b64_tr_b16 v[186:187], v7 offset:27520
  ds_read_b64_tr_b16 v[188:189], v7 offset:27296
  ds_read_b64_tr_b16 v[190:191], v7 offset:27552
  s_waitcnt lgkmcnt(6)
  v_mfma_f32_16x16x32_bf16 v[16:19], v[176:179], v[96:99], v[16:19]
  v_mfma_f32_16x16x32_bf16 v[24:27], v[180:183], v[96:99], v[24:27]
  s_waitcnt vmcnt(0)
  ds_write_b128 v10, v[80:83] offset:29440
  ds_write_b128 v10, v[84:87] offset:30528
  ds_read_b64_tr_b16 v[192:193], v7 offset:29440
  ds_read_b64_tr_b16 v[194:195], v7 offset:29696
  ds_read_b64_tr_b16 v[196:197], v7 offset:29472
  ds_read_b64_tr_b16 v[198:199], v7 offset:29728
  s_waitcnt lgkmcnt(6)
  v_mfma_f32_16x16x32_bf16 v[20:23], v[184:187], v[96:99], v[20:23]
  v_mfma_f32_16x16x32_bf16 v[28:31], v[188:191], v[96:99], v[28:31]
  s_waitcnt lgkmcnt(0)
  v_mfma_f32_16x16x32_bf16 v[16:19], v[192:195], v[100:103], v[16:19]
  v_mfma_f32_16x16x32_bf16 v[24:27], v[196:199], v[100:103], v[24:27]
  s_nop 7
  v_add_f32_dpp v16, v20, v16 row_ror:8 bank_mask:0x3
  v_add_f32_dpp v16, v24, v28 row_ror:8 bank_mask:0xc
  v_add_f32_dpp v17, v21, v17 row_ror:8 bank_mask:0x3
  v_add_f32_dpp v17, v25, v29 row_ror:8 bank_mask:0xc
  v_add_f32_dpp v18, v22, v18 row_ror:8 bank_mask:0x3
  v_add_f32_dpp v18, v26, v30 row_ror:8 bank_mask:0xc
  v_add_f32_dpp v19, v23, v19 row_ror:8 bank_mask:0x3
  v_add_f32_dpp v19, v27, v31 row_ror:8 bank_mask:0xc
  v_bfi_b32 v16, s73, v12, v16
  v_bfi_b32 v17, s73, v12, v17
  v_bfi_b32 v18, s73, v12, v18
  v_bfi_b32 v19, s73, v12, v19
  buffer_store_dwordx4 v[16:19], v8, s[40:43], s45 offen sc1
  s_and_b32 s65, s2, 7
  s_mul_i32 s65, s65, 64
  s_add_u32 s65, s65, 917504
  s_cmp_eq_u32 s31, 20
  s_cselect_b32 s36, 512, 0
  s_cselect_b32 s30, 3, s31
  s_add_u32 s65, s65, s36
  v_mov_b32 v13, s68
  s_cmp_eq_u32 s30, 3
  s_cbranch_scc0 L_ngo
  s_mov_b64 exec, 1
  buffer_store_dwordx2 v[12:13], v14, s[40:43], s65 offen sc1
  s_mov_b64 exec, -1
L_ngo:
  s_sleep 64
  s_mov_b32 s47, -131072
  v_mov_b32 v13, 32
L_qpoll:
  buffer_load_dwordx4 v[200:203], v6, s[40:43], s46 offen sc1
  buffer_load_dwordx4 v[204:207], v6, s[40:43], s46 offen offset:1024 sc1
  s_waitcnt vmcnt(0)
  s_mov_b64 exec, -1
  v_bitop3_b32 v20, v200, v201, v12 bitop3:0x7e
  v_bitop3_b32 v21, v202, v203, v12 bitop3:0x7e
  v_bitop3_b32 v22, v204, v205, v12 bitop3:0x7e
  v_bitop3_b32 v23, v206, v207, v12 bitop3:0x7e
  v_or3_b32 v20, v20, v21, v22
  v_bitop3_b32 v20, v20, s73, v23 bitop3:0xc8
  v_cmp_ne_u32 vcc, 0, v20
  s_cbranch_vccz L_qok
  s_add_u32 s47, s47, 1
  s_cbranch_scc0 L_qpoll
  s_mov_b64 exec, -1
L_qok:
  v_bfi_b32 v200, s73, v13, v200
  v_bfi_b32 v201, s73, v13, v201
  v_bfi_b32 v202, s73, v13, v202
  v_bfi_b32 v203, s73, v13, v203
  v_bfi_b32 v204, s73, v13, v204
  v_bfi_b32 v205, s73, v13, v205
  v_bfi_b32 v206, s73, v13, v206
  v_bfi_b32 v207, s73, v13, v207
  v_pk_add_f32 v[200:201], v[200:201], v[204:205]
  v_pk_add_f32 v[202:203], v[202:203], v[206:207]
  v_cvt_pk_bf16_f32 v200, v200, v201
  v_cvt_pk_bf16_f32 v201, v202, v203
  ds_write_b64 v9, v[200:201] offset:0
L_qdone:
  s_waitcnt lgkmcnt(0)
  s_barrier
  s_mov_b32 s38, 4
  s_mov_b32 s46, 8192
  s_sleep 32
  s_waitcnt vmcnt(0)
  v_mul_u32_u24 v20, 64, v3
  s_mov_b32 s64, 917504
  buffer_load_dwordx2 v[16:17], v20, s[40:43], s64 offen sc1
L_ltw:
  s_mul_i32 s36, s34, 229376
  s_lshl_b32 s30, s38, 7
  s_add_u32 s36, s36, s30
  s_add_u32 s48, s12, s36
  s_addc_u32 s49, s13, 0
  s_and_b32 s49, s49, 0xffff
  s_mov_b32 s50, 228608
  s_mov_b32 s51, 0x20000
  s_mul_i32 s30, s38, 8*10240
  s_add_u32 s72, s72, s30
  v_lshrrev_b32 v4, 3, v0
  v_mul_u32_u24 v4, 896, v4
  v_and_b32 v5, 7, v0
  v_lshl_add_u32 v4, v5, 4, v4
  v_add_u32 v9, s46, v6
  v_bfe_u32 v5, v0, 2, 2
  v_lshlrev_b32 v5, 7, v5
  v_lshrrev_b32 v10, 4, v0
  v_lshl_add_u32 v5, v10, 10, v5
  v_and_b32 v10, 3, v0
  v_lshl_add_u32 v10, v10, 3, v5
  v_add_u32 v10, s46, v10
  s_mov_b32 s44, 0
  s_cmp_lg_u32 s3, 0
  s_cselect_b64 vcc, -1, 0
  buffer_load_dwordx4 v[96:99], v4, s[48:51], s44 offen
  s_add_u32 s44, s44, 8*896
  s_sleep 3
  s_cbranch_vccz L_lp0
  s_sleep 9
L_lp0:
  buffer_load_dwordx4 v[100:103], v4, s[48:51], s44 offen
  s_add_u32 s44, s44, 8*896
  s_sleep 3
  s_cbranch_vccz L_lp1
  s_sleep 9
L_lp1:
  buffer_load_dwordx4 v[104:107], v4, s[48:51], s44 offen
  s_add_u32 s44, s44, 8*896
  s_sleep 3
  s_cbranch_vccz L_lp2
  s_sleep 9
L_lp2:
  buffer_load_dwordx4 v[108:111], v4, s[48:51], s44 offen
  s_add_u32 s44, s44, 8*896
  s_sleep 3
  s_cbranch_vccz L_lp3
  s_sleep 9
L_lp3:
  buffer_load_dwordx4 v[112:115], v4, s[48:51], s44 offen
  s_add_u32 s44, s44, 8*896
  s_sleep 3
  s_cbranch_vccz L_lp4
  s_sleep 9
L_lp4:
  buffer_load_dwordx4 v[116:119], v4, s[48:51], s44 offen
  s_add_u32 s44, s44, 8*896
  s_sleep 3
  s_cbranch_vccz L_lp5
  s_sleep 9
L_lp5:
  buffer_load_dwordx4 v[120:123], v4, s[48:51], s44 offen
  s_add_u32 s44, s44, 8*896
  s_sleep 3
  s_cbranch_vccz L_lp6
  s_sleep 9
L_lp6:
  buffer_load_dwordx4 v[124:127], v4, s[48:51], s44 offen
  s_add_u32 s44, s44, 8*896
  s_sleep 3
  s_cbranch_vccz L_lp7
  s_sleep 9
L_lp7:
  buffer_load_dwordx4 v[128:131], v4, s[48:51], s44 offen
  s_add_u32 s44, s44, 8*896
  s_sleep 3
  s_cbranch_vccz L_lp8
  s_sleep 9
L_lp8:
  buffer_load_dwordx4 v[132:135], v4, s[48:51], s44 offen
  s_add_u32 s44, s44, 8*896
  s_sleep 3
  s_cbranch_vccz L_lp9
  s_sleep 9
L_lp9:
  buffer_load_dwordx4 v[136:139], v4, s[48:51], s44 offen
  s_add_u32 s44, s44, 8*896
  s_sleep 3
  s_cbranch_vccz L_lp10
  s_sleep 9
L_lp10:
  buffer_load_dwordx4 v[140:143], v4, s[48:51], s44 offen
  s_add_u32 s44, s44, 8*896
  s_sleep 3
  s_cbranch_vccz L_lp11
  s_sleep 9
L_lp11:
  buffer_load_dwordx4 v[144:147], v4, s[48:51], s44 offen
  s_add_u32 s44, s44, 8*896
  s_sleep 3
  s_cbranch_vccz L_lp12
  s_sleep 9
L_lp12:
  buffer_load_dwordx4 v[148:151], v4, s[48:51], s44 offen
  s_add_u32 s44, s44, 8*896
  s_sleep 3
  s_cbranch_vccz L_lp13
  s_sleep 9
L_lp13:
  buffer_load_dwordx4 v[152:155], v4, s[48:51], s44 offen
  s_add_u32 s44, s44, 8*896
  s_sleep 3
  s_cbranch_vccz L_lp14
  s_sleep 9
L_lp14:
  buffer_load_dwordx4 v[156:159], v4, s[48:51], s44 offen
  s_add_u32 s44, s44, 8*896
  s_sleep 3
  s_cbranch_vccz L_lp15
  s_sleep 9
L_lp15:
  buffer_load_dwordx4 v[160:163], v4, s[48:51], s44 offen
  s_add_u32 s44, s44, 8*896
  s_sleep 3
  s_cbranch_vccz L_lp16
  s_sleep 9
L_lp16:
  buffer_load_dwordx4 v[164:167], v4, s[48:51], s44 offen
  s_add_u32 s44, s44, 8*896
  s_sleep 3
  s_cbranch_vccz L_lp17
  s_sleep 9
L_lp17:
  buffer_load_dwordx4 v[168:171], v4, s[48:51], s44 offen
  s_add_u32 s44, s44, 8*896
  s_sleep 3
  s_cbranch_vccz L_lp18
  s_sleep 9
L_lp18:
  buffer_load_dwordx4 v[172:175], v4, s[48:51], s44 offen
  s_add_u32 s44, s44, 8*896
  s_sleep 3
  s_cbranch_vccz L_lp19
  s_sleep 9
L_lp19:
  buffer_load_dwordx4 v[176:179], v4, s[48:51], s44 offen
  s_add_u32 s44, s44, 8*896
  s_sleep 3
  s_cbranch_vccz L_lp20
  s_sleep 9
L_lp20:
  buffer_load_dwordx4 v[180:183], v4, s[48:51], s44 offen
  s_add_u32 s44, s44, 8*896
  s_sleep 3
  s_cbranch_vccz L_lp21
  s_sleep 9
L_lp21:
  buffer_load_dwordx4 v[184:187], v4, s[48:51], s44 offen
  s_add_u32 s44, s44, 8*896
  s_sleep 3
  s_cbranch_vccz L_lp22
  s_sleep 9
L_lp22:
  buffer_load_dwordx4 v[188:191], v4, s[48:51], s44 offen
  s_add_u32 s44, s44, 8*896
  s_sleep 3
  s_cbranch_vccz L_lp23
  s_sleep 9
L_lp23:
  buffer_load_dwordx4 v[192:195], v4, s[48:51], s44 offen
  s_add_u32 s44, s44, 8*896
  s_sleep 3
  s_cbranch_vccz L_lp24
  s_sleep 9
L_lp24:
  buffer_load_dwordx4 v[196:199], v4, s[48:51], s44 offen
  s_add_u32 s44, s44, 8*896
  s_sleep 3
  s_cbranch_vccz L_lp25
  s_sleep 9
L_lp25:
  buffer_load_dwordx4 v[200:203], v4, s[48:51], s44 offen
  s_add_u32 s44, s44, 8*896
  s_sleep 3
  s_cbranch_vccz L_lp26
  s_sleep 9
L_lp26:
  buffer_load_dwordx4 v[204:207], v4, s[48:51], s44 offen
  s_add_u32 s44, s44, 8*896
  s_sleep 3
  s_cbranch_vccz L_lp27
  s_sleep 9
L_lp27:
  buffer_load_dwordx4 v[208:211], v4, s[48:51], s44 offen
  s_add_u32 s44, s44, 8*896
  s_sleep 3
  s_cbranch_vccz L_lp28
  s_sleep 9
L_lp28:
  buffer_load_dwordx4 v[212:215], v4, s[48:51], s44 offen
  s_add_u32 s44, s44, 8*896
  s_sleep 3
  s_cbranch_vccz L_lp29
  s_sleep 9
L_lp29:
  buffer_load_dwordx4 v[216:219], v4, s[48:51], s44 offen
  s_add_u32 s44, s44, 8*896
  s_sleep 3
  s_cbranch_vccz L_lp30
  s_sleep 9
L_lp30:
  buffer_load_dwordx4 v[220:223], v4, s[48:51], s44 offen
  s_waitcnt vmcnt(24)
  ds_write_b128 v9, v[96:99] offset:0
  ds_write_b128 v9, v[100:103] offset:1024
  ds_write_b128 v9, v[104:107] offset:2048
  ds_write_b128 v9, v[108:111] offset:3072
  ds_write_b128 v9, v[112:115] offset:4096
  ds_write_b128 v9, v[116:119] offset:5120
  ds_write_b128 v9, v[120:123] offset:6144
  ds_write_b128 v9, v[124:127] offset:7168
  ds_read_b64_tr_b16 v[96:97], v10 offset:0
  ds_read_b64_tr_b16 v[98:99], v10 offset:512
  ds_read_b64_tr_b16 v[104:105], v10 offset:32
  ds_read_b64_tr_b16 v[106:107], v10 offset:544
  ds_read_b64_tr_b16 v[112:113], v10 offset:64
  ds_read_b64_tr_b16 v[114:115], v10 offset:576
  ds_read_b64_tr_b16 v[120:121], v10 offset:96
  ds_read_b64_tr_b16 v[122:123], v10 offset:608
  ds_read_b64_tr_b16 v[100:101], v10 offset:4096
  ds_read_b64_tr_b16 v[102:103], v10 offset:4608
  ds_read_b64_tr_b16 v[108:109], v10 offset:4128
  ds_read_b64_tr_b16 v[110:111], v10 offset:4640
  ds_read_b64_tr_b16 v[116:117], v10 offset:4160
  ds_read_b64_tr_b16 v[118:119], v10 offset:4672
  ds_read_b64_tr_b16 v[124:125], v10 offset:4192
  ds_read_b64_tr_b16 v[126:127], v10 offset:4704
  s_waitcnt vmcnt(16)
  ds_write_b128 v9, v[128:131] offset:0
  ds_write_b128 v9, v[132:135] offset:1024
  ds_write_b128 v9, v[136:139] offset:2048
  ds_write_b128 v9, v[140:143] offset:3072
  ds_write_b128 v9, v[144:147] offset:4096
  ds_write_b128 v9, v[148:151] offset:5120
  ds_write_b128 v9, v[152:155] offset:6144
  ds_write_b128 v9, v[156:159] offset:7168
  ds_read_b64_tr_b16 v[128:129], v10 offset:0
  ds_read_b64_tr_b16 v[130:131], v10 offset:512
  ds_read_b64_tr_b16 v[136:137], v10 offset:32
  ds_read_b64_tr_b16 v[138:139], v10 offset:544
  ds_read_b64_tr_b16 v[144:145], v10 offset:64
  ds_read_b64_tr_b16 v[146:147], v10 offset:576
  ds_read_b64_tr_b16 v[152:153], v10 offset:96
  ds_read_b64_tr_b16 v[154:155], v10 offset:608
  ds_read_b64_tr_b16 v[132:133], v10 offset:4096
  ds_read_b64_tr_b16 v[134:135], v10 offset:4608
  ds_read_b64_tr_b16 v[140:141], v10 offset:4128
  ds_read_b64_tr_b16 v[142:143], v10 offset:4640
  ds_read_b64_tr_b16 v[148:149], v10 offset:4160
  ds_read_b64_tr_b16 v[150:151], v10 offset:4672
  ds_read_b64_tr_b16 v[156:157], v10 offset:4192
  ds_read_b64_tr_b16 v[158:159], v10 offset:4704
  s_waitcnt vmcnt(8)
  ds_write_b128 v9, v[160:163] offset:0
  ds_write_b128 v9, v[164:167] offset:1024
  ds_write_b128 v9, v[168:171] offset:2048
  ds_write_b128 v9, v[172:175] offset:3072
  ds_write_b128 v9, v[176:179] offset:4096
  ds_write_b128 v9, v[180:183] offset:5120
  ds_write_b128 v9, v[184:187] offset:6144
  ds_write_b128 v9, v[188:191] offset:7168
  ds_read_b64_tr_b16 v[160:161], v10 offset:0
  ds_read_b64_tr_b16 v[162:163], v10 offset:512
  ds_read_b64_tr_b16 v[168:169], v10 offset:32
  ds_read_b64_tr_b16 v[170:171], v10 offset:544
  ds_read_b64_tr_b16 v[176:177], v10 offset:64
  ds_read_b64_tr_b16 v[178:179], v10 offset:576
  ds_read_b64_tr_b16 v[184:185], v10 offset:96
  ds_read_b64_tr_b16 v[186:187], v10 offset:608
  ds_read_b64_tr_b16 v[164:165], v10 offset:4096
  ds_read_b64_tr_b16 v[166:167], v10 offset:4608
  ds_read_b64_tr_b16 v[172:173], v10 offset:4128
  ds_read_b64_tr_b16 v[174:175], v10 offset:4640
  ds_read_b64_tr_b16 v[180:181], v10 offset:4160
  ds_read_b64_tr_b16 v[182:183], v10 offset:4672
  ds_read_b64_tr_b16 v[188:189], v10 offset:4192
  ds_read_b64_tr_b16 v[190:191], v10 offset:4704
  s_waitcnt vmcnt(0)
  ds_write_b128 v9, v[192:195] offset:0
  ds_write_b128 v9, v[196:199] offset:1024
  ds_write_b128 v9, v[200:203] offset:2048
  ds_write_b128 v9, v[204:207] offset:3072
  ds_write_b128 v9, v[208:211] offset:4096
  ds_write_b128 v9, v[212:215] offset:5120
  ds_write_b128 v9, v[216:219] offset:6144
  ds_write_b128 v9, v[220:223] offset:7168
  ds_read_b64_tr_b16 v[192:193], v10 offset:0
  ds_read_b64_tr_b16 v[194:195], v10 offset:512
  ds_read_b64_tr_b16 v[200:201], v10 offset:32
  ds_read_b64_tr_b16 v[202:203], v10 offset:544
  ds_read_b64_tr_b16 v[208:209], v10 offset:64
  ds_read_b64_tr_b16 v[210:211], v10 offset:576
  ds_read_b64_tr_b16 v[216:217], v10 offset:96
  ds_read_b64_tr_b16 v[218:219], v10 offset:608
  ds_read_b64_tr_b16 v[196:197], v10 offset:4096
  ds_read_b64_tr_b16 v[198:199], v10 offset:4608
  ds_read_b64_tr_b16 v[204:205], v10 offset:4128
  ds_read_b64_tr_b16 v[206:207], v10 offset:4640
  ds_read_b64_tr_b16 v[212:213], v10 offset:4160
  ds_read_b64_tr_b16 v[214:215], v10 offset:4672
  ds_read_b64_tr_b16 v[220:221], v10 offset:4192
  ds_read_b64_tr_b16 v[222:223], v10 offset:4704
  s_waitcnt lgkmcnt(0)
  s_cmp_lg_u32 s3, 0
  s_cbranch_scc1 L_wstage
  v_mov_b32 v12, 0
  v_mov_b32 v14, s60
  s_movk_i32 s75, 256
  v_cmp_ne_u32 vcc, s60, v16
  v_subrev_u32 v17, s68, v17
  v_cvt_f32_i32 v17, v17
  s_andn2_b32 s30, 0xffff, vcc_lo
  s_bcnt1_i32_b32 s30, s30
  v_cndmask_b32 v17, v17, v12, vcc
  v_cvt_f32_u32 v18, s30
  v_rcp_f32 v18, v18
  v_add_f32_dpp v17, v17, v17 row_ror:8
  s_nop 1
  v_add_f32_dpp v17, v17, v17 row_ror:4
  s_nop 1
  v_add_f32_dpp v17, v17, v17 row_ror:2
  s_nop 1
  v_add_f32_dpp v17, v17, v17 row_ror:1
  s_nop 1
  v_mul_f32 v17, v17, v18
  v_cvt_i32_f32 v17, v17
  s_movk_i32 s76, 2330
  v_readfirstlane_b32 s31, v17
  s_min_i32 s31, s31, 200
  s_max_i32 s31, s31, -200
  s_cmp_lt_u32 s30, 8
  s_cselect_b32 s31, 0, s31
  s_cselect_b32 s76, 0xffff, s76
  s_add_u32 s68, s68, s31
  s_add_u32 s68, s68, 40
  s_lshr_b32 s30, s2, 3
  s_and_b32 s65, s2, 7
  s_mul_i32 s65, s65, 64
  s_add_u32 s65, s65, 918528
  s_mov_b32 s74, 0x7fffffff
  s_cmp_eq_u32 s30, 3
  s_cselect_b32 s74, 2000, s74
  s_cmp_eq_u32 s30, 20
  s_cselect_b32 s74, 2000, s74
  s_cselect_b32 s30, 512, 0
  s_add_u32 s65, s65, s30
  s_mov_b32 s64, 918528
  s_and_b32 s79, s2, 31
  s_mul_i32 s79, s79, 2
  s_add_u32 s79, s79, 2250
  v_mul_u32_u24 v20, 64, v3
  s_mov_b32 s69, 0x7fffffff
  v_and_b32 v3, 3, v0
  v_mul_u32_u24 v3, 544, v3
  v_bfe_u32 v5, v0, 2, 1
  v_mul_u32_u24 v7, 272, v5
  v_add_u32 v3, v3, v7
  v_lshrrev_b32 v7, 4, v0
  v_lshl_add_u32 v3, v7, 4, v3
  v_mul_u32_u24 v5, 0xaaaa, v5
  v_add_u32 v5, 0x4444, v5
  v_lshlrev_b32 v7, 2, v0
  v_mov_b64 v[236:237], 0
  v_mov_b64 v[238:239], 0
  v_mov_b64 v[240:241], 0
  v_mov_b64 v[242:243], 0
  v_mov_b64 v[244:245], 0
  v_mov_b64 v[246:247], 0
  v_mov_b64 v[252:253], 0
  v_mov_b64 v[254:255], 0
L_ct:
  s_sleep 8
  s_memrealtime s[66:67]
  ds_read_b32 v13, v12 offset:560
  s_waitcnt lgkmcnt(0)
  s_sub_u32 s31, s66, s68
  s_add_u32 s67, s31, 40
  s_mul_i32 s67, s67, s76
  s_lshr_b32 s30, s67, 4
  s_sub_u32 s30, s67, s30
  s_add_u32 s30, s30, 573440
  s_max_u32 s67, s67, s30
  s_pack_lh_b32_b16 s67, s75, s67
  v_mov_b32 v18, s67
  ds_write_b32 v12, v18 offset:564
  v_readfirstlane_b32 s30, v13
  s_cmp_ge_u32 s30, s75
  s_cbranch_scc1 L_ctx
  s_cmp_lt_u32 s31, s74
  s_cbranch_scc1 L_ct1
  s_add_u32 s74, s74, 400
  s_pack_ll_b32_b16 s30, s30, s66
  v_mov_b32 v15, s30
  s_mov_b64 exec, 1
  buffer_store_dwordx2 v[14:15], v12, s[40:43], s65 offen sc1
  s_mov_b64 exec, -1
  s_add_u32 s65, s65, 1024
  s_cmp_ge_u32 s65, 983040
  s_cselect_b32 s74, 0x7fffffff, s74
L_ct1:
  s_cmp_lt_u32 s31, s79
  s_cbranch_scc1 L_ct2
  s_add_u32 s79, s79, 400
  s_add_u32 s69, s31, 250
  buffer_load_dwordx2 v[16:17], v20, s[40:43], s64 offen
  s_add_u32 s64, s64, 1024
  s_cmp_ge_u32 s64, 983040
  s_cselect_b32 s79, 0x7fffffff, s79
L_ct2:
  s_cmp_lt_u32 s31, s69
  s_cbranch_scc1 L_ct
  s_mov_b32 s69, 0x7fffffff
  s_waitcnt vmcnt(0)
  v_cmp_ne_u32 vcc, s60, v16
  v_lshrrev_b32 v18, 16, v17
  v_subrev_u32 v18, s68, v18
  v_and_b32 v18, 0xffff, v18
  v_cvt_f32_u32 v18, v18
  v_rcp_f32 v18, v18
  v_and_b32 v17, 0xffff, v17
  v_cvt_f32_u32 v17, v17
  s_not_b32 s30, vcc_lo
  s_bcnt1_i32_b32 s30, s30
  s_cmp_lt_u32 s30, 16
  s_cbranch_scc1 L_ct
  v_mul_f32 v17, v17, v18
  v_cvt_f32_u32 v18, s30
  v_cndmask_b32 v17, v17, v12, vcc
  v_rcp_f32 v18, v18
  s_nop 1
  v_add_f32_dpp v17, v17, v17 row_ror:8
  s_nop 1
  v_add_f32_dpp v17, v17, v17 row_ror:4
  s_nop 1
  v_add_f32_dpp v17, v17, v17 row_ror:2
  s_nop 1
  v_add_f32_dpp v17, v17, v17 row_ror:1
  v_mul_f32 v17, v17, v18
  v_mul_f32 v17, 0x48000000, v17
  v_cvt_u32_f32 v17, v17
  v_min_u32 v17, 0xffff, v17
  s_nop 0
  v_readfirstlane_b32 s76, v17
  s_branch L_ct
L_ctx:
  s_waitcnt vmcnt(0) lgkmcnt(0)
  s_branch L_tail
L_w:
  s_sub_u32 s38, s3, 1
  s_sub_u32 s61, s3, 6
  s_lshl_b32 s46, s61, 16
  s_add_u32 s46, s46, 16384
  s_waitcnt lgkmcnt(0)
  s_lshl1_add_u32 s36, s31, s61
  s_mul_i32 s36, s36, 7*3584
  s_and_b32 s37, s30, 3
  s_mul_i32 s37, s37, 896
  s_add_u32 s36, s36, s37
  s_cmp_lt_u32 s30, 4
  s_cselect_b32 s16, s16, s18
  s_cselect_b32 s17, s17, s19
  s_add_u32 s52, s16, s36
  s_addc_u32 s53, s17, 0
  s_and_b32 s53, s53, 0xffff
  s_mov_b32 s54, 22400
  s_mov_b32 s55, 0x20000
  s_mov_b32 s37, 0
  s_mov_b32 exec_hi, 0xffffff
  buffer_load_dwordx4 v[64:67], v6, s[52:55], s37 offen
  s_add_u32 s37, s37, 3584
  buffer_load_dwordx4 v[68:71], v6, s[52:55], s37 offen
  s_add_u32 s37, s37, 3584
  buffer_load_dwordx4 v[72:75], v6, s[52:55], s37 offen
  s_add_u32 s37, s37, 3584
  buffer_load_dwordx4 v[76:79], v6, s[52:55], s37 offen
  s_add_u32 s37, s37, 3584
  buffer_load_dwordx4 v[80:83], v6, s[52:55], s37 offen
  s_add_u32 s37, s37, 3584
  buffer_load_dwordx4 v[84:87], v6, s[52:55], s37 offen
  s_add_u32 s37, s37, 3584
  buffer_load_dwordx4 v[88:91], v6, s[52:55], s37 offen
  s_mov_b32 exec_hi, -1
  s_lshl1_add_u32 s36, s35, s61
  s_mul_i32 s36, s36, 3136
  s_add_u32 s56, s20, s36
  s_addc_u32 s57, s21, 0
  s_and_b32 s57, s57, 0xffff
  s_mov_b32 s58, 3136
  s_mov_b32 s59, 0x20000
  buffer_load_dwordx4 v[96:99], v6, s[56:59], 0 offen offset:0
  buffer_load_dwordx4 v[100:103], v6, s[56:59], 0 offen offset:1024
  buffer_load_dwordx4 v[104:107], v6, s[56:59], 0 offen offset:2048
  buffer_load_dwordx4 v[108:111], v6, s[56:59], 0 offen offset:3072
  s_lshl1_add_u32 s36, s35, s61
  s_mul_i32 s36, s36, 7168
  s_add_u32 s48, s12, s36
  s_addc_u32 s49, s13, 0
  s_and_b32 s49, s49, 0xffff
  s_mov_b32 s50, 7168
  s_mov_b32 s51, 0x20000
  s_movk_i32 s44, 4096
  buffer_load_dwordx4 v[32:35], v6, s[48:51], 0 offen offset:0
  buffer_load_dwordx4 v[36:39], v6, s[48:51], 0 offen offset:1024
  buffer_load_dwordx4 v[40:43], v6, s[48:51], 0 offen offset:2048
  buffer_load_dwordx4 v[44:47], v6, s[48:51], 0 offen offset:3072
  buffer_load_dwordx4 v[48:51], v6, s[48:51], s44 offen offset:0
  buffer_load_dwordx4 v[52:55], v6, s[48:51], s44 offen offset:1024
  buffer_load_dwordx4 v[56:59], v6, s[48:51], s44 offen offset:2048
  s_barrier
  s_waitcnt lgkmcnt(0)
  s_mov_b32 s40, s28
  s_and_b32 s41, s29, 0xffff
  s_mov_b32 s42, 1048576
  s_mov_b32 s43, 0x20000
  s_barrier
  ds_read_b32 v13, v14 offset:544
  s_sleep 32
  s_sleep 32
  s_waitcnt lgkmcnt(0) vmcnt(0)
  v_readfirstlane_b32 s60, v13
  s_branch L_ltw
L_wstage:
  s_mul_i32 s36, s34, 229376
  s_lshl_b32 s30, s61, 8
  s_add_u32 s36, s36, s30
  s_add_u32 s48, s12, s36
  s_addc_u32 s49, s13, 0
  s_and_b32 s49, s49, 0xffff
  s_mov_b32 s50, 228736
  s_mov_b32 s51, 0x20000
  v_mul_u32_u24 v4, 896, v2
  v_lshl_add_u32 v4, v3, 4, v4
  v_lshrrev_b32 v9, 3, v3
  v_lshlrev_b32 v9, 15, v9
  v_lshl_add_u32 v9, v2, 7, v9
  v_lshl_add_u32 v9, v11, 4, v9
  v_add_u32 v9, s46, v9
  s_mov_b32 s44, 0
L_ws:
  buffer_load_dwordx4 v[32:35], v4, s[48:51], s44 offen
  s_add_u32 s44, s44, 4*896
  s_sleep 12
  buffer_load_dwordx4 v[36:39], v4, s[48:51], s44 offen
  s_add_u32 s44, s44, 4*896
  s_sleep 12
  buffer_load_dwordx4 v[40:43], v4, s[48:51], s44 offen
  s_add_u32 s44, s44, 4*896
  s_sleep 12
  buffer_load_dwordx4 v[44:47], v4, s[48:51], s44 offen
  s_add_u32 s44, s44, 4*896
  s_sleep 12
  buffer_load_dwordx4 v[48:51], v4, s[48:51], s44 offen
  s_add_u32 s44, s44, 4*896
  s_sleep 12
  buffer_load_dwordx4 v[52:55], v4, s[48:51], s44 offen
  s_add_u32 s44, s44, 4*896
  s_sleep 12
  buffer_load_dwordx4 v[56:59], v4, s[48:51], s44 offen
  s_add_u32 s44, s44, 4*896
  s_sleep 12
  buffer_load_dwordx4 v[60:63], v4, s[48:51], s44 offen
  s_add_u32 s44, s44, 4*896
  s_sleep 12
  buffer_load_dwordx4 v[64:67], v4, s[48:51], s44 offen
  s_add_u32 s44, s44, 4*896
  s_sleep 12
  buffer_load_dwordx4 v[68:71], v4, s[48:51], s44 offen
  s_add_u32 s44, s44, 4*896
  s_sleep 12
  buffer_load_dwordx4 v[72:75], v4, s[48:51], s44 offen
  s_add_u32 s44, s44, 4*896
  s_sleep 12
  buffer_load_dwordx4 v[76:79], v4, s[48:51], s44 offen
  s_add_u32 s44, s44, 4*896
  s_sleep 12
  buffer_load_dwordx4 v[80:83], v4, s[48:51], s44 offen
  s_add_u32 s44, s44, 4*896
  s_sleep 12
  buffer_load_dwordx4 v[84:87], v4, s[48:51], s44 offen
  s_add_u32 s44, s44, 4*896
  s_sleep 12
  buffer_load_dwordx4 v[88:91], v4, s[48:51], s44 offen
  s_add_u32 s44, s44, 4*896
  s_sleep 12
  buffer_load_dwordx4 v[92:95], v4, s[48:51], s44 offen
  s_add_u32 s44, s44, 4*896
  s_waitcnt vmcnt(12)
  ds_write_b128 v9, v[32:35] offset:0
  ds_write_b128 v9, v[36:39] offset:512
  ds_write_b128 v9, v[40:43] offset:1024
  ds_write_b128 v9, v[44:47] offset:1536
  s_waitcnt vmcnt(8)
  ds_write_b128 v9, v[48:51] offset:2048
  ds_write_b128 v9, v[52:55] offset:2560
  ds_write_b128 v9, v[56:59] offset:3072
  ds_write_b128 v9, v[60:63] offset:3584
  s_waitcnt vmcnt(4)
  ds_write_b128 v9, v[64:67] offset:4096
  ds_write_b128 v9, v[68:71] offset:4608
  ds_write_b128 v9, v[72:75] offset:5120
  ds_write_b128 v9, v[76:79] offset:5632
  s_waitcnt vmcnt(0)
  ds_write_b128 v9, v[80:83] offset:6144
  ds_write_b128 v9, v[84:87] offset:6656
  ds_write_b128 v9, v[88:91] offset:7168
  ds_write_b128 v9, v[92:95] offset:7680
  v_add_u32 v9, 8192, v9
  s_waitcnt lgkmcnt(0)
  s_cmp_lt_u32 s44, 256*896
  s_cbranch_scc1 L_ws
  v_mov_b32 v13, 1
  s_mov_b64 exec, 1
  ds_add_u32 v14, v13 offset:548
  s_mov_b64 exec, -1
  v_and_b32 v3, 3, v0
  v_mul_u32_u24 v3, 544, v3
  v_bfe_u32 v5, v0, 2, 1
  v_mul_u32_u24 v7, 272, v5
  v_add_u32 v3, v3, v7
  v_lshrrev_b32 v7, 4, v0
  v_lshl_add_u32 v3, v7, 4, v3
  v_mul_u32_u24 v5, 0xaaaa, v5
  v_add_u32 v5, 0x4444, v5
  v_lshlrev_b32 v7, 2, v0
  v_mov_b64 v[236:237], 0
  v_mov_b64 v[238:239], 0
  v_mov_b64 v[240:241], 0
  v_mov_b64 v[242:243], 0
  v_mov_b64 v[244:245], 0
  v_mov_b64 v[246:247], 0
  v_mov_b64 v[252:253], 0
  v_mov_b64 v[254:255], 0
  s_waitcnt lgkmcnt(0)
  s_branch L_tail
L_j:
  s_and_b32 s36, s62, 7
  s_mul_i32 s36, s36, 7
  s_lshr_b32 s37, s62, 3
  s_add_u32 s36, s36, s37
  s_lshl_b32 s37, s33, 6
  s_add_u32 s37, s37, s62
  s_cmp_lt_u32 s37, 56
  s_cselect_b32 s62, s36, s62
  v_mul_u32_u24 v7, 10240, v11
  v_lshl_add_u32 v7, v2, 4, v7
  v_lshrrev_b32 v8, 3, v3
  v_lshl_add_u32 v7, v8, 6, v7
  v_mov_b32 v13, 0
  ds_write_b32 v13, v13 offset:548
  v_mov_b32 v16, 20
  v_mov_b32 v17, 0xffff0100
  ds_write_b64 v13, v[16:17] offset:560
  s_mov_b32 s77, 10
  s_movk_i32 s78, 512
  s_lshl_b32 s79, s32, 12
  s_lshl_b32 s30, s39, 7
  s_add_u32 s79, s79, s30
  s_add_u32 s79, s79, 983040
  s_lshl_b32 s74, s62, 10
  s_add_u32 s74, s74, 8192
  s_sub_u32 s30, s62, 56
  s_lshr_b32 s38, s30, 3
  s_and_b32 s30, s30, 7
  s_mul_i32 s72, s38, 4*20480
  s_lshl_b32 s39, s30, 8
  s_add_u32 s72, s72, s39
  s_add_u32 s72, s72, 335872
  s_lshl_b32 s76, s62, 7
  s_movk_i32 s73, 0xfff
  s_mov_b32 s63, 0
  s_waitcnt lgkmcnt(0)
  s_barrier
  s_mov_b32 s40, s28
  s_and_b32 s41, s29, 0xffff
  s_mov_b32 s42, 1048576
  s_mov_b32 s43, 0x20000
  s_mov_b32 s56, s4
  s_and_b32 s57, s5, 0xffff
  s_mov_b32 s58, 7168
  s_mov_b32 s59, 0x20000
  s_mov_b32 s46, 4096
  s_mov_b32 s44, 0
  s_barrier
  ds_read_b32 v15, v13 offset:544
  s_waitcnt lgkmcnt(0)
  v_readfirstlane_b32 s60, v15
  s_cmp_eq_u32 s33, 1
  s_cbranch_scc1 L_cpre
  s_cmp_ge_u32 s62, 112
  s_cbranch_scc1 L_jend
  s_cmp_ge_u32 s62, 56
  s_cbranch_scc1 L_f2pre
  s_cmp_ge_u32 s62, 28
  s_cselect_b32 s16, s18, s16
  s_cselect_b32 s17, s19, s17
  s_cselect_b32 s30, 28, 0
  s_sub_u32 s30, s62, s30
  s_lshl_b32 s30, s30, 7
  s_add_u32 s48, s16, s30
  s_addc_u32 s49, s17, 0
  s_and_b32 s49, s49, 0xffff
  s_mov_b32 s50, 1602176
  s_mov_b32 s51, 0x20000
  v_mul_u32_u24 v14, 896, v11
  v_lshl_add_u32 v14, v2, 4, v14
  v_mov_b64 v[16:17], 0
  v_mov_b64 v[18:19], 0
  v_mov_b64 v[20:21], 0
  v_mov_b64 v[22:23], 0
  v_mov_b64 v[24:25], 0
  v_mov_b64 v[26:27], 0
  v_mov_b64 v[28:29], 0
  v_mov_b64 v[30:31], 0
  buffer_load_dwordx4 v[144:147], v14, s[56:59], 0 offen offset:0
  buffer_load_dwordx4 v[148:151], v14, s[56:59], 0 offen offset:64
  buffer_load_dwordx4 v[152:155], v14, s[56:59], 0 offen offset:128
  buffer_load_dwordx4 v[156:159], v14, s[56:59], 0 offen offset:192
  buffer_load_dwordx4 v[160:163], v14, s[56:59], 0 offen offset:256
  buffer_load_dwordx4 v[164:167], v14, s[56:59], 0 offen offset:320
  buffer_load_dwordx4 v[168:171], v14, s[56:59], 0 offen offset:384
  s_mov_b32 s45, 3584
  s_mov_b32 s61, 1
  s_mov_b32 s75, 0
L_lt7a:
  v_lshrrev_b32 v4, 3, v0
  v_mul_lo_u32 v4, v4, s45
  v_and_b32 v5, 7, v0
  v_lshl_add_u32 v4, v5, 4, v4
  s_lshl_b32 s45, s45, 3
  v_add_u32 v9, s46, v6
  v_lshrrev_b32 v5, 2, v3
  v_lshlrev_b32 v5, 7, v5
  v_lshl_add_u32 v5, v2, s77, v5
  v_and_b32 v10, 3, v3
  v_lshl_add_u32 v10, v10, 3, v5
  v_add_u32 v10, s46, v10
  v_add_u32 v8, s78, v10
L_lt7:
  buffer_load_dwordx4 v[32:35], v4, s[48:51], s44 offen nt
  s_add_u32 s44, s44, s45
  buffer_load_dwordx4 v[36:39], v4, s[48:51], s44 offen nt
  s_add_u32 s44, s44, s45
  buffer_load_dwordx4 v[40:43], v4, s[48:51], s44 offen nt
  s_add_u32 s44, s44, s45
  buffer_load_dwordx4 v[44:47], v4, s[48:51], s44 offen nt
  s_add_u32 s44, s44, s45
  buffer_load_dwordx4 v[48:51], v4, s[48:51], s44 offen nt
  s_add_u32 s44, s44, s45
  buffer_load_dwordx4 v[52:55], v4, s[48:51], s44 offen nt
  s_add_u32 s44, s44, s45
  buffer_load_dwordx4 v[56:59], v4, s[48:51], s44 offen nt
  s_add_u32 s44, s44, s45
  buffer_load_dwordx4 v[60:63], v4, s[48:51], s44 offen nt
  s_add_u32 s44, s44, s45
  buffer_load_dwordx4 v[64:67], v4, s[48:51], s44 offen nt
  s_add_u32 s44, s44, s45
  buffer_load_dwordx4 v[68:71], v4, s[48:51], s44 offen nt
  s_add_u32 s44, s44, s45
  buffer_load_dwordx4 v[72:75], v4, s[48:51], s44 offen nt
  s_add_u32 s44, s44, s45
  buffer_load_dwordx4 v[76:79], v4, s[48:51], s44 offen nt
  s_add_u32 s44, s44, s45
  buffer_load_dwordx4 v[80:83], v4, s[48:51], s44 offen nt
  s_add_u32 s44, s44, s45
  buffer_load_dwordx4 v[84:87], v4, s[48:51], s44 offen nt
  s_add_u32 s44, s44, s45
  buffer_load_dwordx4 v[88:91], v4, s[48:51], s44 offen nt
  s_add_u32 s44, s44, s45
  buffer_load_dwordx4 v[92:95], v4, s[48:51], s44 offen nt
  s_add_u32 s44, s44, s45
  buffer_load_dwordx4 v[96:99], v4, s[48:51], s44 offen nt
  s_add_u32 s44, s44, s45
  buffer_load_dwordx4 v[100:103], v4, s[48:51], s44 offen nt
  s_add_u32 s44, s44, s45
  buffer_load_dwordx4 v[104:107], v4, s[48:51], s44 offen nt
  s_add_u32 s44, s44, s45
  buffer_load_dwordx4 v[108:111], v4, s[48:51], s44 offen nt
  s_add_u32 s44, s44, s45
  buffer_load_dwordx4 v[112:115], v4, s[48:51], s44 offen nt
  s_add_u32 s44, s44, s45
  buffer_load_dwordx4 v[116:119], v4, s[48:51], s44 offen nt
  s_add_u32 s44, s44, s45
  buffer_load_dwordx4 v[120:123], v4, s[48:51], s44 offen nt
  s_add_u32 s44, s44, s45
  buffer_load_dwordx4 v[124:127], v4, s[48:51], s44 offen nt
  s_add_u32 s44, s44, s45
  buffer_load_dwordx4 v[128:131], v4, s[48:51], s44 offen nt
  s_add_u32 s44, s44, s45
  buffer_load_dwordx4 v[132:135], v4, s[48:51], s44 offen nt
  s_add_u32 s44, s44, s45
  buffer_load_dwordx4 v[136:139], v4, s[48:51], s44 offen nt
  s_add_u32 s44, s44, s45
  buffer_load_dwordx4 v[140:143], v4, s[48:51], s44 offen nt
  s_add_u32 s44, s44, s45
  s_waitcnt vmcnt(24) lgkmcnt(2)
  ds_write_b128 v9, v[32:35] offset:0
  ds_write_b128 v9, v[36:39] offset:1024
  ds_write_b128 v9, v[40:43] offset:2048
  ds_write_b128 v9, v[44:47] offset:3072
  ds_read_b64_tr_b16 v[32:33], v10 offset:0
  ds_read_b64_tr_b16 v[34:35], v8 offset:0
  ds_read_b64_tr_b16 v[36:37], v10 offset:32
  ds_read_b64_tr_b16 v[38:39], v8 offset:32
  ds_read_b64_tr_b16 v[40:41], v10 offset:64
  ds_read_b64_tr_b16 v[42:43], v8 offset:64
  ds_read_b64_tr_b16 v[44:45], v10 offset:96
  ds_read_b64_tr_b16 v[46:47], v8 offset:96
  s_waitcnt vmcnt(20) lgkmcnt(2)
  ds_write_b128 v9, v[48:51] offset:0
  ds_write_b128 v9, v[52:55] offset:1024
  ds_write_b128 v9, v[56:59] offset:2048
  ds_write_b128 v9, v[60:63] offset:3072
  ds_read_b64_tr_b16 v[48:49], v10 offset:0
  ds_read_b64_tr_b16 v[50:51], v8 offset:0
  ds_read_b64_tr_b16 v[52:53], v10 offset:32
  ds_read_b64_tr_b16 v[54:55], v8 offset:32
  ds_read_b64_tr_b16 v[56:57], v10 offset:64
  ds_read_b64_tr_b16 v[58:59], v8 offset:64
  ds_read_b64_tr_b16 v[60:61], v10 offset:96
  ds_read_b64_tr_b16 v[62:63], v8 offset:96
  s_waitcnt vmcnt(16) lgkmcnt(2)
  ds_write_b128 v9, v[64:67] offset:0
  ds_write_b128 v9, v[68:71] offset:1024
  ds_write_b128 v9, v[72:75] offset:2048
  ds_write_b128 v9, v[76:79] offset:3072
  ds_read_b64_tr_b16 v[64:65], v10 offset:0
  ds_read_b64_tr_b16 v[66:67], v8 offset:0
  ds_read_b64_tr_b16 v[68:69], v10 offset:32
  ds_read_b64_tr_b16 v[70:71], v8 offset:32
  ds_read_b64_tr_b16 v[72:73], v10 offset:64
  ds_read_b64_tr_b16 v[74:75], v8 offset:64
  ds_read_b64_tr_b16 v[76:77], v10 offset:96
  ds_read_b64_tr_b16 v[78:79], v8 offset:96
  s_waitcnt vmcnt(12) lgkmcnt(2)
  ds_write_b128 v9, v[80:83] offset:0
  ds_write_b128 v9, v[84:87] offset:1024
  ds_write_b128 v9, v[88:91] offset:2048
  ds_write_b128 v9, v[92:95] offset:3072
  ds_read_b64_tr_b16 v[80:81], v10 offset:0
  ds_read_b64_tr_b16 v[82:83], v8 offset:0
  ds_read_b64_tr_b16 v[84:85], v10 offset:32
  ds_read_b64_tr_b16 v[86:87], v8 offset:32
  ds_read_b64_tr_b16 v[88:89], v10 offset:64
  ds_read_b64_tr_b16 v[90:91], v8 offset:64
  ds_read_b64_tr_b16 v[92:93], v10 offset:96
  ds_read_b64_tr_b16 v[94:95], v8 offset:96
  s_waitcnt vmcnt(8) lgkmcnt(2)
  ds_write_b128 v9, v[96:99] offset:0
  ds_write_b128 v9, v[100:103] offset:1024
  ds_write_b128 v9, v[104:107] offset:2048
  ds_write_b128 v9, v[108:111] offset:3072
  ds_read_b64_tr_b16 v[96:97], v10 offset:0
  ds_read_b64_tr_b16 v[98:99], v8 offset:0
  ds_read_b64_tr_b16 v[100:101], v10 offset:32
  ds_read_b64_tr_b16 v[102:103], v8 offset:32
  ds_read_b64_tr_b16 v[104:105], v10 offset:64
  ds_read_b64_tr_b16 v[106:107], v8 offset:64
  ds_read_b64_tr_b16 v[108:109], v10 offset:96
  ds_read_b64_tr_b16 v[110:111], v8 offset:96
  s_waitcnt vmcnt(4) lgkmcnt(2)
  ds_write_b128 v9, v[112:115] offset:0
  ds_write_b128 v9, v[116:119] offset:1024
  ds_write_b128 v9, v[120:123] offset:2048
  ds_write_b128 v9, v[124:127] offset:3072
  ds_read_b64_tr_b16 v[112:113], v10 offset:0
  ds_read_b64_tr_b16 v[114:115], v8 offset:0
  ds_read_b64_tr_b16 v[116:117], v10 offset:32
  ds_read_b64_tr_b16 v[118:119], v8 offset:32
  ds_read_b64_tr_b16 v[120:121], v10 offset:64
  ds_read_b64_tr_b16 v[122:123], v8 offset:64
  ds_read_b64_tr_b16 v[124:125], v10 offset:96
  ds_read_b64_tr_b16 v[126:127], v8 offset:96
  s_waitcnt vmcnt(0) lgkmcnt(2)
  ds_write_b128 v9, v[128:131] offset:0
  ds_write_b128 v9, v[132:135] offset:1024
  ds_write_b128 v9, v[136:139] offset:2048
  ds_write_b128 v9, v[140:143] offset:3072
  ds_read_b64_tr_b16 v[128:129], v10 offset:0
  ds_read_b64_tr_b16 v[130:131], v8 offset:0
  ds_read_b64_tr_b16 v[132:133], v10 offset:32
  ds_read_b64_tr_b16 v[134:135], v8 offset:32
  ds_read_b64_tr_b16 v[136:137], v10 offset:64
  ds_read_b64_tr_b16 v[138:139], v8 offset:64
  ds_read_b64_tr_b16 v[140:141], v10 offset:96
  ds_read_b64_tr_b16 v[142:143], v8 offset:96
  s_waitcnt lgkmcnt(0)
  s_cmp_eq_u32 s61, 2
  s_cbranch_scc1 L_f2
L_mm7:
  v_mfma_f32_16x16x32_bf16 v[16:19], v[32:35], v[144:147], v[16:19]
  v_mfma_f32_16x16x32_bf16 v[20:23], v[36:39], v[144:147], v[20:23]
  v_mfma_f32_16x16x32_bf16 v[24:27], v[40:43], v[144:147], v[24:27]
  v_mfma_f32_16x16x32_bf16 v[28:31], v[44:47], v[144:147], v[28:31]
  v_mfma_f32_16x16x32_bf16 v[16:19], v[48:51], v[148:151], v[16:19]
  v_mfma_f32_16x16x32_bf16 v[20:23], v[52:55], v[148:151], v[20:23]
  v_mfma_f32_16x16x32_bf16 v[24:27], v[56:59], v[148:151], v[24:27]
  v_mfma_f32_16x16x32_bf16 v[28:31], v[60:63], v[148:151], v[28:31]
  v_mfma_f32_16x16x32_bf16 v[16:19], v[64:67], v[152:155], v[16:19]
  v_mfma_f32_16x16x32_bf16 v[20:23], v[68:71], v[152:155], v[20:23]
  v_mfma_f32_16x16x32_bf16 v[24:27], v[72:75], v[152:155], v[24:27]
  v_mfma_f32_16x16x32_bf16 v[28:31], v[76:79], v[152:155], v[28:31]
  v_mfma_f32_16x16x32_bf16 v[16:19], v[80:83], v[156:159], v[16:19]
  v_mfma_f32_16x16x32_bf16 v[20:23], v[84:87], v[156:159], v[20:23]
  v_mfma_f32_16x16x32_bf16 v[24:27], v[88:91], v[156:159], v[24:27]
  v_mfma_f32_16x16x32_bf16 v[28:31], v[92:95], v[156:159], v[28:31]
  v_mfma_f32_16x16x32_bf16 v[16:19], v[96:99], v[160:163], v[16:19]
  v_mfma_f32_16x16x32_bf16 v[20:23], v[100:103], v[160:163], v[20:23]
  v_mfma_f32_16x16x32_bf16 v[24:27], v[104:107], v[160:163], v[24:27]
  v_mfma_f32_16x16x32_bf16 v[28:31], v[108:111], v[160:163], v[28:31]
  v_mfma_f32_16x16x32_bf16 v[16:19], v[112:115], v[164:167], v[16:19]
  v_mfma_f32_16x16x32_bf16 v[20:23], v[116:119], v[164:167], v[20:23]
  v_mfma_f32_16x16x32_bf16 v[24:27], v[120:123], v[164:167], v[24:27]
  v_mfma_f32_16x16x32_bf16 v[28:31], v[124:127], v[164:167], v[28:31]
  v_mfma_f32_16x16x32_bf16 v[16:19], v[128:131], v[168:171], v[16:19]
  v_mfma_f32_16x16x32_bf16 v[20:23], v[132:135], v[168:171], v[20:23]
  v_mfma_f32_16x16x32_bf16 v[24:27], v[136:139], v[168:171], v[24:27]
  v_mfma_f32_16x16x32_bf16 v[28:31], v[140:143], v[168:171], v[28:31]
  s_nop 7
  s_cmp_eq_u32 s61, 2
  s_cbranch_scc1 L_f2post
  s_cmp_eq_u32 s75, 1
  s_cbranch_scc1 L_f1post
  s_mov_b32 s75, 1
  buffer_load_dwordx4 v[144:147], v14, s[56:59], 0 offen offset:448
  buffer_load_dwordx4 v[148:151], v14, s[56:59], 0 offen offset:512
  buffer_load_dwordx4 v[152:155], v14, s[56:59], 0 offen offset:576
  buffer_load_dwordx4 v[156:159], v14, s[56:59], 0 offen offset:640
  buffer_load_dwordx4 v[160:163], v14, s[56:59], 0 offen offset:704
  buffer_load_dwordx4 v[164:167], v14, s[56:59], 0 offen offset:768
  buffer_load_dwordx4 v[168:171], v14, s[56:59], 0 offen offset:832
  s_branch L_lt7
L_f1post:
  s_cmp_ge_u32 s62, 28
  s_cbranch_scc1 L_f1pub
  v_cvt_pk_bf16_f32 v17, v16, v17
  v_lshlrev_b32 v16, 16, v17
  v_and_b32 v17, 0xffff0000, v17
  v_mul_f32 v32, 0xbfb8aa3b, v16
  v_mul_f32 v33, 0xbfb8aa3b, v17
  v_exp_f32 v32, v32
  v_exp_f32 v33, v33
  v_add_f32 v32, 1.0, v32
  v_add_f32 v33, 1.0, v33
  v_rcp_f32 v32, v32
  v_rcp_f32 v33, v33
  s_nop 0
  v_pk_mul_f32 v[16:17], v[16:17], v[32:33]
  v_cvt_pk_bf16_f32 v19, v18, v19
  v_lshlrev_b32 v18, 16, v19
  v_and_b32 v19, 0xffff0000, v19
  v_mul_f32 v32, 0xbfb8aa3b, v18
  v_mul_f32 v33, 0xbfb8aa3b, v19
  v_exp_f32 v32, v32
  v_exp_f32 v33, v33
  v_add_f32 v32, 1.0, v32
  v_add_f32 v33, 1.0, v33
  v_rcp_f32 v32, v32
  v_rcp_f32 v33, v33
  s_nop 0
  v_pk_mul_f32 v[18:19], v[18:19], v[32:33]
  v_cvt_pk_bf16_f32 v21, v20, v21
  v_lshlrev_b32 v20, 16, v21
  v_and_b32 v21, 0xffff0000, v21
  v_mul_f32 v32, 0xbfb8aa3b, v20
  v_mul_f32 v33, 0xbfb8aa3b, v21
  v_exp_f32 v32, v32
  v_exp_f32 v33, v33
  v_add_f32 v32, 1.0, v32
  v_add_f32 v33, 1.0, v33
  v_rcp_f32 v32, v32
  v_rcp_f32 v33, v33
  s_nop 0
  v_pk_mul_f32 v[20:21], v[20:21], v[32:33]
  v_cvt_pk_bf16_f32 v23, v22, v23
  v_lshlrev_b32 v22, 16, v23
  v_and_b32 v23, 0xffff0000, v23
  v_mul_f32 v32, 0xbfb8aa3b, v22
  v_mul_f32 v33, 0xbfb8aa3b, v23
  v_exp_f32 v32, v32
  v_exp_f32 v33, v33
  v_add_f32 v32, 1.0, v32
  v_add_f32 v33, 1.0, v33
  v_rcp_f32 v32, v32
  v_rcp_f32 v33, v33
  s_nop 0
  v_pk_mul_f32 v[22:23], v[22:23], v[32:33]
  v_cvt_pk_bf16_f32 v25, v24, v25
  v_lshlrev_b32 v24, 16, v25
  v_and_b32 v25, 0xffff0000, v25
  v_mul_f32 v32, 0xbfb8aa3b, v24
  v_mul_f32 v33, 0xbfb8aa3b, v25
  v_exp_f32 v32, v32
  v_exp_f32 v33, v33
  v_add_f32 v32, 1.0, v32
  v_add_f32 v33, 1.0, v33
  v_rcp_f32 v32, v32
  v_rcp_f32 v33, v33
  s_nop 0
  v_pk_mul_f32 v[24:25], v[24:25], v[32:33]
  v_cvt_pk_bf16_f32 v27, v26, v27
  v_lshlrev_b32 v26, 16, v27
  v_and_b32 v27, 0xffff0000, v27
  v_mul_f32 v32, 0xbfb8aa3b, v26
  v_mul_f32 v33, 0xbfb8aa3b, v27
  v_exp_f32 v32, v32
  v_exp_f32 v33, v33
  v_add_f32 v32, 1.0, v32
  v_add_f32 v33, 1.0, v33
  v_rcp_f32 v32, v32
  v_rcp_f32 v33, v33
  s_nop 0
  v_pk_mul_f32 v[26:27], v[26:27], v[32:33]
  v_cvt_pk_bf16_f32 v29, v28, v29
  v_lshlrev_b32 v28, 16, v29
  v_and_b32 v29, 0xffff0000, v29
  v_mul_f32 v32, 0xbfb8aa3b, v28
  v_mul_f32 v33, 0xbfb8aa3b, v29
  v_exp_f32 v32, v32
  v_exp_f32 v33, v33
  v_add_f32 v32, 1.0, v32
  v_add_f32 v33, 1.0, v33
  v_rcp_f32 v32, v32
  v_rcp_f32 v33, v33
  s_nop 0
  v_pk_mul_f32 v[28:29], v[28:29], v[32:33]
  v_cvt_pk_bf16_f32 v31, v30, v31
  v_lshlrev_b32 v30, 16, v31
  v_and_b32 v31, 0xffff0000, v31
  v_mul_f32 v32, 0xbfb8aa3b, v30
  v_mul_f32 v33, 0xbfb8aa3b, v31
  v_exp_f32 v32, v32
  v_exp_f32 v33, v33
  v_add_f32 v32, 1.0, v32
  v_add_f32 v33, 1.0, v33
  v_rcp_f32 v32, v32
  v_rcp_f32 v33, v33
  s_nop 0
  v_pk_mul_f32 v[30:31], v[30:31], v[32:33]
L_f1pub:
  v_lshlrev_b32 v14, 6, v3
  v_lshl_add_u32 v14, v2, 4, v14
  v_cvt_pk_bf16_f32 v32, v16, v17
  v_cvt_pk_bf16_f32 v33, v18, v19
  v_cvt_pk_bf16_f32 v34, v20, v21
  v_cvt_pk_bf16_f32 v35, v22, v23
  v_cvt_pk_bf16_f32 v36, v24, v25
  v_cvt_pk_bf16_f32 v37, v26, v27
  v_cvt_pk_bf16_f32 v38, v28, v29
  v_cvt_pk_bf16_f32 v39, v30, v31
  s_nop 1
  v_mov_b32_dpp v32, v36 quad_perm:[0,1,2,3] bank_mask:0xc
  v_mov_b32_dpp v33, v37 quad_perm:[0,1,2,3] bank_mask:0xc
  v_mov_b32_dpp v34, v38 quad_perm:[0,1,2,3] bank_mask:0xc
  v_mov_b32_dpp v35, v39 quad_perm:[0,1,2,3] bank_mask:0xc
  buffer_store_dwordx4 v[32:35], v14, s[40:43], s74 offen sc1
  s_mov_b64 exec, 1
  s_waitcnt vmcnt(0)
  buffer_store_dword v15, v6, s[40:43], s76 offen offset:1024 sc1
  s_mov_b64 exec, -1
  s_branch L_jend
L_f2pre:
  s_mul_i32 s36, s30, 224*896
  s_lshl_b32 s37, s38, 7
  s_add_u32 s36, s36, s37
  s_add_u32 s48, s20, s36
  s_addc_u32 s49, s21, 0
  s_and_b32 s49, s49, 0xffff
  s_mov_b32 s50, 199936
  s_mov_b32 s51, 0x20000
  s_mul_i32 s75, s30, 7*512
  s_add_u32 s75, s75, 8192
  s_add_u32 s74, s75, 28*1024
  s_mul_i32 s76, s30, 7
  s_lshr_b32 s76, s76, 1
  s_lshl_b32 s76, s76, 7
  s_mov_b32 s77, 9
  s_movk_i32 s78, 2048
  s_mov_b32 s45, 896
  s_mov_b32 s61, 2
  s_branch L_lt7a
L_f2:
  v_lshlrev_b32 v14, 6, v11
  v_lshl_add_u32 v14, v2, 4, v14
  v_and_b32 v13, 3, v0
  v_bfe_u32 v16, v0, 2, 1
  v_mad_u32_u24 v13, v16, 28, v13
  v_lshlrev_b32 v13, 7, v13
  s_mov_b32 s47, 0
L_f2poll:
  buffer_load_dword v16, v13, s[40:43], s76 offen offset:1024 sc1
  s_waitcnt vmcnt(0)
  v_cmp_ne_u32 vcc, s60, v16
  s_cbranch_vccz L_f2pollx
  s_sleep 64
  s_add_u32 s47, s47, 1
  s_cmp_lt_u32 s47, 131072
  s_cbranch_scc1 L_f2poll
L_f2pollx:
  buffer_load_dwordx4 v[144:147], v14, s[40:43], s75 offen offset:0 sc1
  buffer_load_dwordx4 v[172:175], v14, s[40:43], s74 offen offset:0 sc1
  buffer_load_dwordx4 v[148:151], v14, s[40:43], s75 offen offset:512 sc1
  buffer_load_dwordx4 v[176:179], v14, s[40:43], s74 offen offset:512 sc1
  buffer_load_dwordx4 v[152:155], v14, s[40:43], s75 offen offset:1024 sc1
  buffer_load_dwordx4 v[180:183], v14, s[40:43], s74 offen offset:1024 sc1
  buffer_load_dwordx4 v[156:159], v14, s[40:43], s75 offen offset:1536 sc1
  buffer_load_dwordx4 v[184:187], v14, s[40:43], s74 offen offset:1536 sc1
  buffer_load_dwordx4 v[160:163], v14, s[40:43], s75 offen offset:2048 sc1
  buffer_load_dwordx4 v[188:191], v14, s[40:43], s74 offen offset:2048 sc1
  buffer_load_dwordx4 v[164:167], v14, s[40:43], s75 offen offset:2560 sc1
  buffer_load_dwordx4 v[192:195], v14, s[40:43], s74 offen offset:2560 sc1
  buffer_load_dwordx4 v[168:171], v14, s[40:43], s75 offen offset:3072 sc1
  buffer_load_dwordx4 v[196:199], v14, s[40:43], s74 offen offset:3072 sc1
  s_waitcnt vmcnt(0)
  v_lshlrev_b32 v16, 16, v144
  v_and_b32 v17, 0xffff0000, v144
  v_lshlrev_b32 v18, 16, v172
  v_and_b32 v19, 0xffff0000, v172
  v_pk_mul_f32 v[16:17], v[16:17], v[18:19]
  v_cvt_pk_bf16_f32 v144, v16, v17
  v_lshlrev_b32 v16, 16, v145
  v_and_b32 v17, 0xffff0000, v145
  v_lshlrev_b32 v18, 16, v173
  v_and_b32 v19, 0xffff0000, v173
  v_pk_mul_f32 v[16:17], v[16:17], v[18:19]
  v_cvt_pk_bf16_f32 v145, v16, v17
  v_lshlrev_b32 v16, 16, v146
  v_and_b32 v17, 0xffff0000, v146
  v_lshlrev_b32 v18, 16, v174
  v_and_b32 v19, 0xffff0000, v174
  v_pk_mul_f32 v[16:17], v[16:17], v[18:19]
  v_cvt_pk_bf16_f32 v146, v16, v17
  v_lshlrev_b32 v16, 16, v147
  v_and_b32 v17, 0xffff0000, v147
  v_lshlrev_b32 v18, 16, v175
  v_and_b32 v19, 0xffff0000, v175
  v_pk_mul_f32 v[16:17], v[16:17], v[18:19]
  v_cvt_pk_bf16_f32 v147, v16, v17
  v_lshlrev_b32 v16, 16, v148
  v_and_b32 v17, 0xffff0000, v148
  v_lshlrev_b32 v18, 16, v176
  v_and_b32 v19, 0xffff0000, v176
  v_pk_mul_f32 v[16:17], v[16:17], v[18:19]
  v_cvt_pk_bf16_f32 v148, v16, v17
  v_lshlrev_b32 v16, 16, v149
  v_and_b32 v17, 0xffff0000, v149
  v_lshlrev_b32 v18, 16, v177
  v_and_b32 v19, 0xffff0000, v177
  v_pk_mul_f32 v[16:17], v[16:17], v[18:19]
  v_cvt_pk_bf16_f32 v149, v16, v17
  v_lshlrev_b32 v16, 16, v150
  v_and_b32 v17, 0xffff0000, v150
  v_lshlrev_b32 v18, 16, v178
  v_and_b32 v19, 0xffff0000, v178
  v_pk_mul_f32 v[16:17], v[16:17], v[18:19]
  v_cvt_pk_bf16_f32 v150, v16, v17
  v_lshlrev_b32 v16, 16, v151
  v_and_b32 v17, 0xffff0000, v151
  v_lshlrev_b32 v18, 16, v179
  v_and_b32 v19, 0xffff0000, v179
  v_pk_mul_f32 v[16:17], v[16:17], v[18:19]
  v_cvt_pk_bf16_f32 v151, v16, v17
  v_lshlrev_b32 v16, 16, v152
  v_and_b32 v17, 0xffff0000, v152
  v_lshlrev_b32 v18, 16, v180
  v_and_b32 v19, 0xffff0000, v180
  v_pk_mul_f32 v[16:17], v[16:17], v[18:19]
  v_cvt_pk_bf16_f32 v152, v16, v17
  v_lshlrev_b32 v16, 16, v153
  v_and_b32 v17, 0xffff0000, v153
  v_lshlrev_b32 v18, 16, v181
  v_and_b32 v19, 0xffff0000, v181
  v_pk_mul_f32 v[16:17], v[16:17], v[18:19]
  v_cvt_pk_bf16_f32 v153, v16, v17
  v_lshlrev_b32 v16, 16, v154
  v_and_b32 v17, 0xffff0000, v154
  v_lshlrev_b32 v18, 16, v182
  v_and_b32 v19, 0xffff0000, v182
  v_pk_mul_f32 v[16:17], v[16:17], v[18:19]
  v_cvt_pk_bf16_f32 v154, v16, v17
  v_lshlrev_b32 v16, 16, v155
  v_and_b32 v17, 0xffff0000, v155
  v_lshlrev_b32 v18, 16, v183
  v_and_b32 v19, 0xffff0000, v183
  v_pk_mul_f32 v[16:17], v[16:17], v[18:19]
  v_cvt_pk_bf16_f32 v155, v16, v17
  v_lshlrev_b32 v16, 16, v156
  v_and_b32 v17, 0xffff0000, v156
  v_lshlrev_b32 v18, 16, v184
  v_and_b32 v19, 0xffff0000, v184
  v_pk_mul_f32 v[16:17], v[16:17], v[18:19]
  v_cvt_pk_bf16_f32 v156, v16, v17
  v_lshlrev_b32 v16, 16, v157
  v_and_b32 v17, 0xffff0000, v157
  v_lshlrev_b32 v18, 16, v185
  v_and_b32 v19, 0xffff0000, v185
  v_pk_mul_f32 v[16:17], v[16:17], v[18:19]
  v_cvt_pk_bf16_f32 v157, v16, v17
  v_lshlrev_b32 v16, 16, v158
  v_and_b32 v17, 0xffff0000, v158
  v_lshlrev_b32 v18, 16, v186
  v_and_b32 v19, 0xffff0000, v186
  v_pk_mul_f32 v[16:17], v[16:17], v[18:19]
  v_cvt_pk_bf16_f32 v158, v16, v17
  v_lshlrev_b32 v16, 16, v159
  v_and_b32 v17, 0xffff0000, v159
  v_lshlrev_b32 v18, 16, v187
  v_and_b32 v19, 0xffff0000, v187
  v_pk_mul_f32 v[16:17], v[16:17], v[18:19]
  v_cvt_pk_bf16_f32 v159, v16, v17
  v_lshlrev_b32 v16, 16, v160
  v_and_b32 v17, 0xffff0000, v160
  v_lshlrev_b32 v18, 16, v188
  v_and_b32 v19, 0xffff0000, v188
  v_pk_mul_f32 v[16:17], v[16:17], v[18:19]
  v_cvt_pk_bf16_f32 v160, v16, v17
  v_lshlrev_b32 v16, 16, v161
  v_and_b32 v17, 0xffff0000, v161
  v_lshlrev_b32 v18, 16, v189
  v_and_b32 v19, 0xffff0000, v189
  v_pk_mul_f32 v[16:17], v[16:17], v[18:19]
  v_cvt_pk_bf16_f32 v161, v16, v17
  v_lshlrev_b32 v16, 16, v162
  v_and_b32 v17, 0xffff0000, v162
  v_lshlrev_b32 v18, 16, v190
  v_and_b32 v19, 0xffff0000, v190
  v_pk_mul_f32 v[16:17], v[16:17], v[18:19]
  v_cvt_pk_bf16_f32 v162, v16, v17
  v_lshlrev_b32 v16, 16, v163
  v_and_b32 v17, 0xffff0000, v163
  v_lshlrev_b32 v18, 16, v191
  v_and_b32 v19, 0xffff0000, v191
  v_pk_mul_f32 v[16:17], v[16:17], v[18:19]
  v_cvt_pk_bf16_f32 v163, v16, v17
  v_lshlrev_b32 v16, 16, v164
  v_and_b32 v17, 0xffff0000, v164
  v_lshlrev_b32 v18, 16, v192
  v_and_b32 v19, 0xffff0000, v192
  v_pk_mul_f32 v[16:17], v[16:17], v[18:19]
  v_cvt_pk_bf16_f32 v164, v16, v17
  v_lshlrev_b32 v16, 16, v165
  v_and_b32 v17, 0xffff0000, v165
  v_lshlrev_b32 v18, 16, v193
  v_and_b32 v19, 0xffff0000, v193
  v_pk_mul_f32 v[16:17], v[16:17], v[18:19]
  v_cvt_pk_bf16_f32 v165, v16, v17
  v_lshlrev_b32 v16, 16, v166
  v_and_b32 v17, 0xffff0000, v166
  v_lshlrev_b32 v18, 16, v194
  v_and_b32 v19, 0xffff0000, v194
  v_pk_mul_f32 v[16:17], v[16:17], v[18:19]
  v_cvt_pk_bf16_f32 v166, v16, v17
  v_lshlrev_b32 v16, 16, v167
  v_and_b32 v17, 0xffff0000, v167
  v_lshlrev_b32 v18, 16, v195
  v_and_b32 v19, 0xffff0000, v195
  v_pk_mul_f32 v[16:17], v[16:17], v[18:19]
  v_cvt_pk_bf16_f32 v167, v16, v17
  v_lshlrev_b32 v16, 16, v168
  v_and_b32 v17, 0xffff0000, v168
  v_lshlrev_b32 v18, 16, v196
  v_and_b32 v19, 0xffff0000, v196
  v_pk_mul_f32 v[16:17], v[16:17], v[18:19]
  v_cvt_pk_bf16_f32 v168, v16, v17
  v_lshlrev_b32 v16, 16, v169
  v_and_b32 v17, 0xffff0000, v169
  v_lshlrev_b32 v18, 16, v197
  v_and_b32 v19, 0xffff0000, v197
  v_pk_mul_f32 v[16:17], v[16:17], v[18:19]
  v_cvt_pk_bf16_f32 v169, v16, v17
  v_lshlrev_b32 v16, 16, v170
  v_and_b32 v17, 0xffff0000, v170
  v_lshlrev_b32 v18, 16, v198
  v_and_b32 v19, 0xffff0000, v198
  v_pk_mul_f32 v[16:17], v[16:17], v[18:19]
  v_cvt_pk_bf16_f32 v170, v16, v17
  v_lshlrev_b32 v16, 16, v171
  v_and_b32 v17, 0xffff0000, v171
  v_lshlrev_b32 v18, 16, v199
  v_and_b32 v19, 0xffff0000, v199
  v_pk_mul_f32 v[16:17], v[16:17], v[18:19]
  v_cvt_pk_bf16_f32 v171, v16, v17
  v_mov_b64 v[16:17], 0
  v_mov_b64 v[18:19], 0
  v_mov_b64 v[20:21], 0
  v_mov_b64 v[22:23], 0
  v_mov_b64 v[24:25], 0
  v_mov_b64 v[26:27], 0
  v_mov_b64 v[28:29], 0
  v_mov_b64 v[30:31], 0
  s_nop 0
  s_branch L_mm7
L_f2post:
  v_mov_b32_dpp v16, v20 quad_perm:[0,1,2,3] bank_mask:0xc
  v_mov_b32_dpp v17, v21 quad_perm:[0,1,2,3] bank_mask:0xc
  v_mov_b32_dpp v18, v22 quad_perm:[0,1,2,3] bank_mask:0xc
  v_mov_b32_dpp v19, v23 quad_perm:[0,1,2,3] bank_mask:0xc
  v_bfi_b32 v16, s73, v15, v16
  v_bfi_b32 v17, s73, v15, v17
  v_bfi_b32 v18, s73, v15, v18
  v_bfi_b32 v19, s73, v15, v19
  buffer_store_dwordx4 v[16:19], v7, s[40:43], s72 offen offset:0 sc1
  v_mov_b32_dpp v24, v28 quad_perm:[0,1,2,3] bank_mask:0xc
  v_mov_b32_dpp v25, v29 quad_perm:[0,1,2,3] bank_mask:0xc
  v_mov_b32_dpp v26, v30 quad_perm:[0,1,2,3] bank_mask:0xc
  v_mov_b32_dpp v27, v31 quad_perm:[0,1,2,3] bank_mask:0xc
  v_bfi_b32 v24, s73, v15, v24
  v_bfi_b32 v25, s73, v15, v25
  v_bfi_b32 v26, s73, v15, v26
  v_bfi_b32 v27, s73, v15, v27
  buffer_store_dwordx4 v[24:27], v7, s[40:43], s72 offen offset:128 sc1
  s_branch L_jend
L_cpre:
  s_cmp_ge_u32 s62, 112
  s_cbranch_scc1 L_jend
  s_and_b32 s36, s62, 7
  s_mov_b32 s48, s22
  s_and_b32 s49, s23, 0xffff
  s_mov_b32 s50, 896
  s_mov_b32 s51, 0x20000
  s_mul_i32 s44, s36, 896
  buffer_load_dwordx4 v[32:35], v6, s[56:59], s44 offen
  buffer_load_dwordx4 v[48:51], v6, s[48:51], 0 offen
  v_and_b32 v7, 7, v0
  v_lshlrev_b32 v9, 3, v7
  v_and_b32 v10, 1, v2
  v_lshl_add_u32 v9, v10, 2, v9
  v_lshrrev_b32 v10, 1, v2
  v_lshl_add_u32 v9, v10, 1, v9
  v_lshrrev_b32 v4, 3, v0
  v_lshlrev_b32 v7, 4, v7
  v_lshl_add_u32 v7, v4, 8, v7
  v_and_b32 v10, 3, v0
  v_lshl_add_u32 v10, v10, 3, v4
  v_lshlrev_b32 v10, 7, v10
  s_lshr_b32 s37, s62, 3
  s_lshl_b32 s45, s37, 6
  s_add_u32 s45, s44, s45
  s_mov_b32 s52, s24
  s_and_b32 s53, s25, 0xffff
  s_mov_b32 s54, 7168
  s_mov_b32 s55, 0x20000
  s_lshr_b32 s46, s37, 1
  s_lshl3_add_u32 s46, s46, s36
  s_mul_i32 s46, s46, 10240
  s_and_b32 s37, s37, 1
  s_lshl_b32 s37, s37, 7
  s_add_u32 s46, s46, s37
  s_add_u32 s46, s46, 327680
  v_mov_b32 v14, 0
  v_mov_b32 v8, s60
  v_cmp_gt_u32 vcc, 56, v0
  s_waitcnt vmcnt(0)
  s_add_u32 s48, s46, 4096
  s_add_u32 s49, s46, 8192
  s_lshl_b32 s58, s36, 12
  s_add_u32 s58, s58, 983040
  v_lshlrev_b32 v16, 16, v32
  v_and_b32 v17, 0xffff0000, v32
  v_lshlrev_b32 v18, 16, v48
  v_and_b32 v19, 0xffff0000, v48
  v_pk_mul_f32 v[16:17], v[16:17], v[18:19]
  v_cvt_pk_bf16_f32 v17, v16, v17
  v_lshlrev_b32 v16, 16, v17
  v_and_b32 v17, 0xffff0000, v17
  v_add_f32 v14, v14, v16
  v_add_f32 v14, v14, v17
  v_lshlrev_b32 v16, 16, v33
  v_and_b32 v17, 0xffff0000, v33
  v_lshlrev_b32 v18, 16, v49
  v_and_b32 v19, 0xffff0000, v49
  v_pk_mul_f32 v[16:17], v[16:17], v[18:19]
  v_cvt_pk_bf16_f32 v17, v16, v17
  v_lshlrev_b32 v16, 16, v17
  v_and_b32 v17, 0xffff0000, v17
  v_add_f32 v14, v14, v16
  v_add_f32 v14, v14, v17
  v_lshlrev_b32 v16, 16, v34
  v_and_b32 v17, 0xffff0000, v34
  v_lshlrev_b32 v18, 16, v50
  v_and_b32 v19, 0xffff0000, v50
  v_pk_mul_f32 v[16:17], v[16:17], v[18:19]
  v_cvt_pk_bf16_f32 v17, v16, v17
  v_lshlrev_b32 v16, 16, v17
  v_and_b32 v17, 0xffff0000, v17
  v_add_f32 v14, v14, v16
  v_add_f32 v14, v14, v17
  v_lshlrev_b32 v16, 16, v35
  v_and_b32 v17, 0xffff0000, v35
  v_lshlrev_b32 v18, 16, v51
  v_and_b32 v19, 0xffff0000, v51
  v_pk_mul_f32 v[16:17], v[16:17], v[18:19]
  v_cvt_pk_bf16_f32 v17, v16, v17
  v_lshlrev_b32 v16, 16, v17
  v_and_b32 v17, 0xffff0000, v17
  v_add_f32 v14, v14, v16
  v_add_f32 v14, v14, v17
  v_cndmask_b32 v14, 0, v14, vcc
  s_nop 1
  v_add_f32_dpp v14, v14, v14 row_ror:1
  s_nop 1
  v_add_f32_dpp v14, v14, v14 row_ror:2
  s_nop 1
  v_add_f32_dpp v14, v14, v14 row_ror:4
  s_nop 1
  v_add_f32_dpp v14, v14, v14 row_ror:8
  v_mov_b32 v12, v14
  s_nop 1
  v_permlane16_swap_b32 v14, v12
  v_add_f32 v14, v14, v12
  v_mov_b32 v12, v14
  s_nop 1
  v_permlane32_swap_b32 v14, v12
  v_add_f32 v14, v14, v12
  v_cvt_pk_bf16_f32 v14, v14, v14
  v_lshlrev_b32 v14, 16, v14
  v_mul_f32 v14, 0xbfb8aa3b, v14
  v_exp_f32 v14, v14
  s_nop 0
  v_add_f32 v14, 1.0, v14
  v_rcp_f32 v14, v14
  s_nop 0
  v_cvt_pk_bf16_f32 v14, v14, v14
  v_lshlrev_b32 v14, 16, v14
  v_sub_f32 v12, 1.0, v14
  v_cvt_pk_bf16_f32 v12, v12, v12
  v_lshlrev_b32 v12, 16, v12
L_cw:
  s_sleep 32
  ds_read_b32 v16, v13 offset:560
  s_waitcnt lgkmcnt(0)
  v_readfirstlane_b32 s30, v16
  s_cmp_lt_u32 s30, 128
  s_cbranch_scc1 L_cw
  s_mov_b32 s47, 0
L_cd:
  buffer_load_dwordx4 v[32:35], v7, s[40:43], s49 offen sc1
  s_waitcnt vmcnt(0)
  v_bitop3_b32 v16, v32, v33, v8 bitop3:0x7e
  v_bitop3_b32 v17, v34, v35, v8 bitop3:0x7e
  v_bitop3_b32 v16, v16, s73, v17 bitop3:0xc8
  v_cmp_ne_u32 vcc, 0, v16
  s_cbranch_vccz L_cf2
  s_sleep 64
  s_add_u32 s47, s47, 1
  s_cmp_lt_u32 s47, 131072
  s_cbranch_scc1 L_cd
L_cf2:
  s_nop 1
  v_permlane32_swap_b32 v32, v33
  v_permlane32_swap_b32 v34, v35
  v_add_f32 v32, v32, v33
  v_add_f32 v34, v34, v35
  s_nop 1
  v_permlane16_swap_b32 v32, v34
  v_add_f32 v32, v32, v34
  s_nop 1
  v_add_f32_dpp v32, v32, v32 row_ror:8
  v_cvt_pk_bf16_f32 v32, v32, v32
  v_lshlrev_b32 v32, 16, v32
  v_mul_f32 v12, v12, v32
  v_cvt_pk_bf16_f32 v12, v12, v12
  v_lshlrev_b32 v12, 16, v12
  s_mov_b64 s[64:65], -1
  s_mov_b64 s[66:67], -1
  s_mov_b64 s[68:69], -1
  s_mov_b64 s[70:71], -1
  s_mov_b64 s[56:57], -1
  v_not_b32 v32, v8
  v_not_b32 v33, v8
  v_not_b32 v34, v8
  v_not_b32 v35, v8
  v_not_b32 v36, v8
  v_not_b32 v37, v8
  v_not_b32 v38, v8
  v_not_b32 v39, v8
  v_not_b32 v40, v8
  v_not_b32 v41, v8
  v_not_b32 v42, v8
  v_not_b32 v43, v8
  v_not_b32 v44, v8
  v_not_b32 v45, v8
  v_not_b32 v46, v8
  v_not_b32 v47, v8
  v_not_b32 v65, v8
  v_not_b32 v67, v8
  s_mov_b32 s50, 0xff00ff
  s_mov_b32 s51, s50
  s_mov_b32 s63, 1
L_cw2:
  s_sleep 8
  ds_read_b32 v16, v13 offset:560
  s_waitcnt lgkmcnt(0)
  v_readfirstlane_b32 s30, v16
  s_cmp_lt_u32 s30, 260
  s_cbranch_scc1 L_cw2
  s_mov_b64 exec, s[56:57]
  buffer_load_dwordx4 v[64:67], v10, s[40:43], s58 offen sc1
  s_mov_b64 exec, s[64:65]
  buffer_load_dwordx4 v[32:35], v7, s[40:43], s46 offen offset:0 sc1
  s_mov_b64 exec, s[66:67]
  buffer_load_dwordx4 v[36:39], v7, s[40:43], s46 offen offset:2048 sc1
  s_mov_b64 exec, s[68:69]
  buffer_load_dwordx4 v[40:43], v7, s[40:43], s48 offen offset:0 sc1
  s_mov_b64 exec, s[70:71]
  buffer_load_dwordx4 v[44:47], v7, s[40:43], s48 offen offset:2048 sc1
  s_mov_b64 exec, -1
L_jend:
  v_mov_b32 v13, 0
  v_mov_b32 v17, s60
  v_mov_b32 v19, s60
  s_mov_b32 s47, -2097152
  s_cmp_eq_u32 s63, 0
  s_barrier
  ds_read_b128 v[24:27], v13 offset:512
  ds_read_b128 v[28:31], v13 offset:528
  s_cbranch_scc1 L_npb
  s_mov_b64 exec, s[56:57]
  buffer_load_dwordx4 v[64:67], v10, s[40:43], s58 offen sc1
  s_mov_b64 exec, s[64:65]
  buffer_load_dwordx4 v[32:35], v7, s[40:43], s46 offen offset:0 sc1
  s_mov_b64 exec, s[66:67]
  buffer_load_dwordx4 v[36:39], v7, s[40:43], s46 offen offset:2048 sc1
  s_mov_b64 exec, s[68:69]
  buffer_load_dwordx4 v[40:43], v7, s[40:43], s48 offen offset:0 sc1
  s_mov_b64 exec, s[70:71]
  buffer_load_dwordx4 v[44:47], v7, s[40:43], s48 offen offset:2048 sc1
  s_mov_b64 exec, -1
L_npb:
  s_waitcnt lgkmcnt(0)
  v_max3_f32 v16, v24, v26, v28
  v_max_f32 v16, v16, v30
  v_mul_f32 v18, 0xbdb8aa3b, v16
  v_fmamk_f32 v24, v24, 0x3db8aa3b, v18
  v_fmamk_f32 v26, v26, 0x3db8aa3b, v18
  v_fmamk_f32 v28, v28, 0x3db8aa3b, v18
  v_fmamk_f32 v30, v30, 0x3db8aa3b, v18
  v_exp_f32 v24, v24
  v_exp_f32 v26, v26
  v_exp_f32 v28, v28
  v_exp_f32 v30, v30
  v_mul_f32 v18, v24, v25
  v_fmac_f32 v18, v26, v27
  v_fmac_f32 v18, v28, v29
  v_fmac_f32 v18, v30, v31
  s_mov_b64 exec, 1
  buffer_store_dwordx4 v[16:19], v13, s[40:43], s79 offen sc1
  s_cmp_eq_u32 s63, 0
  s_cbranch_scc1 L_endw
  s_mov_b64 exec, -1
  s_waitcnt vmcnt(1)
L_c1:
  v_bitop3_b32 v76, v65, v67, v8 bitop3:0x7e
  v_cmp_ne_u32 s[56:57], 0, v76
  v_bitop3_b32 v76, v32, v33, v8 bitop3:0x7e
  v_bitop3_b32 v77, v34, v35, v8 bitop3:0x7e
  v_bitop3_b32 v76, v76, s73, v77 bitop3:0xc8
  v_cmp_ne_u32 s[64:65], 0, v76
  v_bitop3_b32 v76, v36, v37, v8 bitop3:0x7e
  v_bitop3_b32 v77, v38, v39, v8 bitop3:0x7e
  v_bitop3_b32 v76, v76, s73, v77 bitop3:0xc8
  v_cmp_ne_u32 s[66:67], 0, v76
  v_bitop3_b32 v76, v40, v41, v8 bitop3:0x7e
  v_bitop3_b32 v77, v42, v43, v8 bitop3:0x7e
  v_bitop3_b32 v76, v76, s73, v77 bitop3:0xc8
  v_cmp_ne_u32 s[68:69], 0, v76
  v_bitop3_b32 v76, v44, v45, v8 bitop3:0x7e
  v_bitop3_b32 v77, v46, v47, v8 bitop3:0x7e
  v_bitop3_b32 v76, v76, s73, v77 bitop3:0xc8
  v_cmp_ne_u32 s[70:71], 0, v76
  s_cmp_eq_u64 s[56:57], 0
  s_cbranch_scc1 L_c1x
  s_bcnt1_i32_b64 s30, s[64:65]
  s_bcnt1_i32_b64 s31, s[66:67]
  s_add_u32 s30, s30, s31
  s_bcnt1_i32_b64 s31, s[68:69]
  s_add_u32 s30, s30, s31
  s_bcnt1_i32_b64 s31, s[70:71]
  s_add_u32 s30, s30, s31
  s_add_u32 s47, s47, 1
  s_cbranch_scc1 L_c1x
  s_cmp_gt_u32 s30, 64
  s_cbranch_scc1 L_c1s
  s_mov_b64 exec, s[56:57]
  buffer_load_dwordx4 v[64:67], v10, s[40:43], s58 offen sc1
  s_mov_b64 exec, s[64:65]
  buffer_load_dwordx4 v[32:35], v7, s[40:43], s46 offen offset:0 sc1
  s_mov_b64 exec, s[66:67]
  buffer_load_dwordx4 v[36:39], v7, s[40:43], s46 offen offset:2048 sc1
  s_mov_b64 exec, s[68:69]
  buffer_load_dwordx4 v[40:43], v7, s[40:43], s48 offen offset:0 sc1
  s_mov_b64 exec, s[70:71]
  buffer_load_dwordx4 v[44:47], v7, s[40:43], s48 offen offset:2048 sc1
  s_mov_b64 exec, -1
  s_waitcnt vmcnt(35)
  s_branch L_c1
L_c1s:
  s_cmp_le_u32 s30, 128
  s_cbranch_scc1 L_c1a
  s_sleep 8
L_c1a:
  s_mov_b64 exec, s[56:57]
  buffer_load_dwordx4 v[64:67], v10, s[40:43], s58 offen sc1
  s_mov_b64 exec, s[64:65]
  buffer_load_dwordx4 v[32:35], v7, s[40:43], s46 offen offset:0 sc1
  s_mov_b64 exec, s[66:67]
  buffer_load_dwordx4 v[36:39], v7, s[40:43], s46 offen offset:2048 sc1
  s_mov_b64 exec, s[68:69]
  buffer_load_dwordx4 v[40:43], v7, s[40:43], s48 offen offset:0 sc1
  s_mov_b64 exec, s[70:71]
  buffer_load_dwordx4 v[44:47], v7, s[40:43], s48 offen offset:2048 sc1
  s_mov_b64 exec, -1
  s_waitcnt vmcnt(0)
  s_branch L_c1
L_c1x:
  s_mov_b64 exec, s[64:65]
  buffer_load_dwordx4 v[32:35], v7, s[40:43], s46 offen offset:0 sc1
  s_mov_b64 exec, s[66:67]
  buffer_load_dwordx4 v[36:39], v7, s[40:43], s46 offen offset:2048 sc1
  s_mov_b64 exec, s[68:69]
  buffer_load_dwordx4 v[40:43], v7, s[40:43], s48 offen offset:0 sc1
  s_mov_b64 exec, s[70:71]
  buffer_load_dwordx4 v[44:47], v7, s[40:43], s48 offen offset:2048 sc1
  s_mov_b64 exec, -1
  s_or_b32 s47, s47, -2097152
  v_mov_b32_dpp v77, v66 quad_perm:[1,0,3,2]
  v_mov_b32_dpp v76, v64 quad_perm:[1,0,3,2]
  v_max_f32 v78, v64, v76
  v_mul_f32 v78, 0xbdb8aa3b, v78
  v_fmamk_f32 v79, v64, 0x3db8aa3b, v78
  v_fmamk_f32 v76, v76, 0x3db8aa3b, v78
  v_exp_f32 v79, v79
  v_exp_f32 v76, v76
  v_mul_f32 v78, v79, v66
  v_fmac_f32 v78, v76, v77
  v_rcp_f32 v78, v78
  s_nop 0
  v_mul_f32 v78, v78, v79
  s_nop 1
  v_mov_b32_dpp v68, v78 quad_perm:[0,0,0,0]
  v_mov_b32_dpp v69, v78 quad_perm:[1,1,1,1]
  v_mov_b32_dpp v70, v78 quad_perm:[2,2,2,2]
  v_mov_b32_dpp v71, v78 quad_perm:[3,3,3,3]
L_c2:
  v_bitop3_b32 v76, v32, v33, v8 bitop3:0x7e
  v_bitop3_b32 v77, v34, v35, v8 bitop3:0x7e
  v_bitop3_b32 v76, v76, s73, v77 bitop3:0xc8
  v_cmp_ne_u32 s[64:65], 0, v76
  v_pk_mul_f32 v[16:17], v[32:33], v[68:69] op_sel:[0,0] op_sel_hi:[1,0]
  v_pk_mul_f32 v[18:19], v[34:35], v[68:69] op_sel:[0,0] op_sel_hi:[1,0]
  v_bitop3_b32 v76, v36, v37, v8 bitop3:0x7e
  v_bitop3_b32 v77, v38, v39, v8 bitop3:0x7e
  v_bitop3_b32 v76, v76, s73, v77 bitop3:0xc8
  v_cmp_ne_u32 s[66:67], 0, v76
  v_pk_fma_f32 v[16:17], v[36:37], v[68:69], v[16:17] op_sel:[0,1,0] op_sel_hi:[1,1,1]
  v_pk_fma_f32 v[18:19], v[38:39], v[68:69], v[18:19] op_sel:[0,1,0] op_sel_hi:[1,1,1]
  s_or_b64 s[30:31], s[64:65], s[66:67]
  v_bitop3_b32 v76, v40, v41, v8 bitop3:0x7e
  v_bitop3_b32 v77, v42, v43, v8 bitop3:0x7e
  v_bitop3_b32 v76, v76, s73, v77 bitop3:0xc8
  v_cmp_ne_u32 s[68:69], 0, v76
  v_pk_fma_f32 v[16:17], v[40:41], v[70:71], v[16:17] op_sel:[0,0,0] op_sel_hi:[1,0,1]
  v_pk_fma_f32 v[18:19], v[42:43], v[70:71], v[18:19] op_sel:[0,0,0] op_sel_hi:[1,0,1]
  s_or_b64 s[30:31], s[30:31], s[68:69]
  v_bitop3_b32 v76, v44, v45, v8 bitop3:0x7e
  v_bitop3_b32 v77, v46, v47, v8 bitop3:0x7e
  v_bitop3_b32 v76, v76, s73, v77 bitop3:0xc8
  v_cmp_ne_u32 s[70:71], 0, v76
  v_pk_fma_f32 v[16:17], v[44:45], v[70:71], v[16:17] op_sel:[0,1,0] op_sel_hi:[1,1,1]
  v_pk_fma_f32 v[18:19], v[46:47], v[70:71], v[18:19] op_sel:[0,1,0] op_sel_hi:[1,1,1]
  s_or_b64 s[30:31], s[30:31], s[70:71]
  s_cbranch_scc1 L_cretry
L_cok:
  v_permlane32_swap_b32 v16, v17
  v_permlane32_swap_b32 v18, v19
  v_add_f32 v16, v16, v17
  v_add_f32 v18, v18, v19
  s_nop 1
  v_permlane16_swap_b32 v16, v18
  v_add_f32 v16, v16, v18
  s_nop 1
  v_add_f32_dpp v16, v16, v16 row_ror:8
  v_cvt_pk_bf16_f32 v16, v16, v16
  v_lshlrev_b32 v16, 16, v16
  v_mul_f32 v16, v14, v16
  v_cvt_pk_bf16_f32 v16, v16, v16
  v_lshlrev_b32 v16, 16, v16
  v_add_f32 v16, v16, v12
  v_cvt_pk_bf16_f32 v16, v16, v16
  s_mov_b64 exec, s[50:51]
  buffer_store_short v16, v9, s[52:55], s45 offen
  s_cmp_lg_u32 s62, 0
  s_cbranch_scc1 L_endw
  s_mov_b64 exec, 1
  buffer_store_dword v8, v6, s[40:43], 0 offen offset:0 sc1
L_endw:
  s_endpgm
L_cretry:
  s_bcnt1_i32_b64 s30, s[64:65]
  s_bcnt1_i32_b64 s31, s[66:67]
  s_add_u32 s30, s30, s31
  s_bcnt1_i32_b64 s31, s[68:69]
  s_add_u32 s30, s30, s31
  s_bcnt1_i32_b64 s31, s[70:71]
  s_add_u32 s30, s30, s31
  s_add_u32 s47, s47, 1
  s_cbranch_scc1 L_cok
  s_cmp_gt_u32 s30, 64
  s_cbranch_scc1 L_c2s
  s_mov_b64 exec, s[64:65]
  buffer_load_dwordx4 v[32:35], v7, s[40:43], s46 offen offset:0 sc1
  s_mov_b64 exec, s[66:67]
  buffer_load_dwordx4 v[36:39], v7, s[40:43], s46 offen offset:2048 sc1
  s_mov_b64 exec, s[68:69]
  buffer_load_dwordx4 v[40:43], v7, s[40:43], s48 offen offset:0 sc1
  s_mov_b64 exec, s[70:71]
  buffer_load_dwordx4 v[44:47], v7, s[40:43], s48 offen offset:2048 sc1
  s_mov_b64 exec, -1
  s_waitcnt vmcnt(28)
  s_branch L_c2
L_c2s:
  s_cmp_le_u32 s30, 128
  s_cbranch_scc1 L_c2a
  s_sleep 8
L_c2a:
  s_mov_b64 exec, s[64:65]
  buffer_load_dwordx4 v[32:35], v7, s[40:43], s46 offen offset:0 sc1
  s_mov_b64 exec, s[66:67]
  buffer_load_dwordx4 v[36:39], v7, s[40:43], s46 offen offset:2048 sc1
  s_mov_b64 exec, s[68:69]
  buffer_load_dwordx4 v[40:43], v7, s[40:43], s48 offen offset:0 sc1
  s_mov_b64 exec, s[70:71]
  buffer_load_dwordx4 v[44:47], v7, s[40:43], s48 offen offset:2048 sc1
  s_mov_b64 exec, -1
  s_waitcnt vmcnt(0)
  s_branch L_c2
.p2align 6
L_stream:
  v_lshlrev_b32 v4, 9, v2
  v_lshl_add_u32 v4, v3, 4, v4
  s_lshl4_add_u32 s36, s32, s34
  s_lshl_b32 s36, s36, 21
  s_mov_b32 s45, 2097152
  s_lshl_b32 s65, s33, 14
  s_mov_b32 s66, s38
  s_bfe_u32 s64, s66, 0x10000
  s_lshl_b32 s64, s64, 12
  s_xor_b32 s44, s64, s65
  s_bfe_u32 s64, s66, 0x10001
  s_lshl_b32 s64, s64, 16
  s_xor_b32 s44, s64, s44
  s_bfe_u32 s64, s66, 0x10002
  s_lshl_b32 s64, s64, 15
  s_xor_b32 s44, s64, s44
  s_bfe_u32 s64, s66, 0x40003
  s_lshl_b32 s64, s64, 17
  s_xor_b32 s44, s64, s44
  s_add_u32 s67, s44, 8192
  s_waitcnt lgkmcnt(0)
  s_add_u32 s48, s6, s36
  s_addc_u32 s49, s7, 0
  s_and_b32 s49, s49, 0xffff
  s_mov_b32 s50, s45
  s_mov_b32 s51, 0x20000
  s_barrier
  buffer_load_dwordx4 v[32:35], v4, s[48:51], s44 offen offset:0 nt
  buffer_load_dwordx4 v[36:39], v4, s[48:51], s44 offen offset:256 nt
  buffer_load_dwordx4 v[40:43], v4, s[48:51], s67 offen offset:0 nt
  buffer_load_dwordx4 v[44:47], v4, s[48:51], s67 offen offset:256 nt
  buffer_load_dwordx4 v[48:51], v4, s[48:51], s44 offen offset:2048 nt
  buffer_load_dwordx4 v[52:55], v4, s[48:51], s44 offen offset:2304 nt
  buffer_load_dwordx4 v[56:59], v4, s[48:51], s67 offen offset:2048 nt
  buffer_load_dwordx4 v[60:63], v4, s[48:51], s67 offen offset:2304 nt
  s_add_u32 s66, s66, 4
  s_bfe_u32 s64, s66, 0x10000
  s_lshl_b32 s64, s64, 12
  s_xor_b32 s44, s64, s65
  s_bfe_u32 s64, s66, 0x10001
  s_lshl_b32 s64, s64, 16
  s_xor_b32 s44, s64, s44
  s_bfe_u32 s64, s66, 0x10002
  s_lshl_b32 s64, s64, 15
  s_xor_b32 s44, s64, s44
  s_bfe_u32 s64, s66, 0x40003
  s_lshl_b32 s64, s64, 17
  s_xor_b32 s44, s64, s44
  s_add_u32 s67, s44, 8192
  buffer_load_dwordx4 v[64:67], v4, s[48:51], s44 offen offset:0 nt
  buffer_load_dwordx4 v[68:71], v4, s[48:51], s44 offen offset:256 nt
  buffer_load_dwordx4 v[72:75], v4, s[48:51], s67 offen offset:0 nt
  buffer_load_dwordx4 v[76:79], v4, s[48:51], s67 offen offset:256 nt
  buffer_load_dwordx4 v[80:83], v4, s[48:51], s44 offen offset:2048 nt
  buffer_load_dwordx4 v[84:87], v4, s[48:51], s44 offen offset:2304 nt
  buffer_load_dwordx4 v[88:91], v4, s[48:51], s67 offen offset:2048 nt
  buffer_load_dwordx4 v[92:95], v4, s[48:51], s67 offen offset:2304 nt
  s_add_u32 s66, s66, 4
  s_bfe_u32 s64, s66, 0x10000
  s_lshl_b32 s64, s64, 12
  s_xor_b32 s44, s64, s65
  s_bfe_u32 s64, s66, 0x10001
  s_lshl_b32 s64, s64, 16
  s_xor_b32 s44, s64, s44
  s_bfe_u32 s64, s66, 0x10002
  s_lshl_b32 s64, s64, 15
  s_xor_b32 s44, s64, s44
  s_bfe_u32 s64, s66, 0x40003
  s_lshl_b32 s64, s64, 17
  s_xor_b32 s44, s64, s44
  s_add_u32 s67, s44, 8192
  buffer_load_dwordx4 v[96:99], v4, s[48:51], s44 offen offset:0 nt
  buffer_load_dwordx4 v[100:103], v4, s[48:51], s44 offen offset:256 nt
  buffer_load_dwordx4 v[104:107], v4, s[48:51], s67 offen offset:0 nt
  buffer_load_dwordx4 v[108:111], v4, s[48:51], s67 offen offset:256 nt
  buffer_load_dwordx4 v[112:115], v4, s[48:51], s44 offen offset:2048 nt
  buffer_load_dwordx4 v[116:119], v4, s[48:51], s44 offen offset:2304 nt
  buffer_load_dwordx4 v[120:123], v4, s[48:51], s67 offen offset:2048 nt
  buffer_load_dwordx4 v[124:127], v4, s[48:51], s67 offen offset:2304 nt
  s_add_u32 s66, s66, 4
  s_bfe_u32 s64, s66, 0x10000
  s_lshl_b32 s64, s64, 12
  s_xor_b32 s44, s64, s65
  s_bfe_u32 s64, s66, 0x10001
  s_lshl_b32 s64, s64, 16
  s_xor_b32 s44, s64, s44
  s_bfe_u32 s64, s66, 0x10002
  s_lshl_b32 s64, s64, 15
  s_xor_b32 s44, s64, s44
  s_bfe_u32 s64, s66, 0x40003
  s_lshl_b32 s64, s64, 17
  s_xor_b32 s44, s64, s44
  s_add_u32 s67, s44, 8192
  buffer_load_dwordx4 v[128:131], v4, s[48:51], s44 offen offset:0 nt
  buffer_load_dwordx4 v[132:135], v4, s[48:51], s44 offen offset:256 nt
  buffer_load_dwordx4 v[136:139], v4, s[48:51], s67 offen offset:0 nt
  buffer_load_dwordx4 v[140:143], v4, s[48:51], s67 offen offset:256 nt
  buffer_load_dwordx4 v[144:147], v4, s[48:51], s44 offen offset:2048 nt
  buffer_load_dwordx4 v[148:151], v4, s[48:51], s44 offen offset:2304 nt
  buffer_load_dwordx4 v[152:155], v4, s[48:51], s67 offen offset:2048 nt
  buffer_load_dwordx4 v[156:159], v4, s[48:51], s67 offen offset:2304 nt
  s_add_u32 s66, s66, 4
  s_bfe_u32 s64, s66, 0x10000
  s_lshl_b32 s64, s64, 12
  s_xor_b32 s44, s64, s65
  s_bfe_u32 s64, s66, 0x10001
  s_lshl_b32 s64, s64, 16
  s_xor_b32 s44, s64, s44
  s_bfe_u32 s64, s66, 0x10002
  s_lshl_b32 s64, s64, 15
  s_xor_b32 s44, s64, s44
  s_bfe_u32 s64, s66, 0x40003
  s_lshl_b32 s64, s64, 17
  s_xor_b32 s44, s64, s44
  s_add_u32 s67, s44, 8192
  buffer_load_dwordx4 v[160:163], v4, s[48:51], s44 offen offset:0 nt
  buffer_load_dwordx4 v[164:167], v4, s[48:51], s44 offen offset:256 nt
  buffer_load_dwordx4 v[168:171], v4, s[48:51], s67 offen offset:0 nt
  buffer_load_dwordx4 v[172:175], v4, s[48:51], s67 offen offset:256 nt
  buffer_load_dwordx4 v[176:179], v4, s[48:51], s44 offen offset:2048 nt
  buffer_load_dwordx4 v[180:183], v4, s[48:51], s44 offen offset:2304 nt
  buffer_load_dwordx4 v[184:187], v4, s[48:51], s67 offen offset:2048 nt
  buffer_load_dwordx4 v[188:191], v4, s[48:51], s67 offen offset:2304 nt
  s_mov_b64 s[54:55], s[48:49]
  s_add_u32 s52, s8, s36
  s_addc_u32 s53, s9, 0
  s_and_b32 s53, s53, 0xffff
  s_mov_b32 s40, s28
  s_and_b32 s41, s29, 0xffff
  s_mov_b32 s42, 1048576
  s_mov_b32 s43, 0x20000
  s_mul_i32 s30, s38, 8*10240
  s_add_u32 s72, s72, s30
  s_lshl_b32 s30, s38, 11
  s_add_u32 s30, s30, 147456
  v_lshlrev_b32 v8, 4, v0
  v_add_u32 v8, s30, v8
  v_mov_b64 v[12:13], -1
  v_mov_b64 v[14:15], -1
  ds_write_b128 v8, v[12:15]
  ds_write_b128 v8, v[12:15] offset:1024
  s_lshl_b32 s79, s38, 6
  s_add_u32 s79, s79, 139264
  v_and_b32 v8, 1, v0
  v_lshlrev_b32 v8, 4, v8
  v_mov_b32 v9, 0xffff
  v_lshlrev_b32 v1, v8, v9
  v_and_b32 v8, 2, v0
  v_cmp_eq_u32 vcc, 0, v8
  s_nop 1
  v_cndmask_b32 v1, 0, v1, vcc
  v_and_b32 v8, 1, v2
  v_mul_u32_u24 v6, 272, v8
  v_lshl_add_u32 v6, v3, 3, v6
  v_lshrrev_b32 v8, 1, v2
  v_lshl_add_u32 v6, v8, 2, v6
  s_mul_i32 s30, s38, 544
  s_add_u32 s30, s30, 1024
  v_add_u32 v6, s30, v6
  v_lshlrev_b32 v224, 4, v3
  s_waitcnt lgkmcnt(0)
  v_mov_b64 v[8:9], 0
  v_mov_b64 v[10:11], 0
  v_mov_b64 v[12:13], 0
  v_mov_b64 v[14:15], 0
  v_mov_b64 v[16:17], 0
  v_mov_b64 v[18:19], 0
  v_mov_b64 v[20:21], 0
  v_mov_b64 v[22:23], 0
  v_mov_b32 v233, 0
  v_mov_b32 v228, 0x7149f2ca
  v_mov_b32 v229, v228
  v_mov_b32 v234, 0x3db8aa3b
  v_mov_b32 v235, 0xbdb8aa3b
  s_mov_b32 s61, 0xff7fffff
  s_mov_b32 s46, 2
  s_movk_i32 s71, 180
  v_mov_b32 v250, 1
  v_mov_b32 v251, 0
  s_lshl_b32 s30, s38, 3
  v_mov_b32 v2, s30
  v_and_b32 v3, 3, v0
  v_mul_u32_u24 v3, 544, v3
  v_bfe_u32 v5, v0, 2, 1
  v_mul_u32_u24 v7, 272, v5
  v_add_u32 v3, v3, v7
  v_lshrrev_b32 v7, 4, v0
  v_lshl_add_u32 v3, v7, 4, v3
  v_mul_u32_u24 v5, 0xaaaa, v5
  v_add_u32 v5, 0x4444, v5
  v_lshlrev_b32 v7, 2, v0
  v_mov_b64 v[236:237], 0
  v_mov_b64 v[238:239], 0
  v_mov_b64 v[240:241], 0
  v_mov_b64 v[242:243], 0
  v_mov_b64 v[244:245], 0
  v_mov_b64 v[246:247], 0
  v_mov_b64 v[252:253], 0
  v_mov_b64 v[254:255], 0
  s_barrier
  ds_read_b128 v[24:27], v224 offset:0
  ds_read_b128 v[28:31], v224 offset:256
  ds_read_b32 v226, v251 offset:544
  s_mov_b64 exec, 1
  ds_add_rtn_u64 v[248:249], v251, v[250:251] offset:560
  s_mov_b64 exec, -1
  s_waitcnt lgkmcnt(0)
  v_readfirstlane_b32 s60, v226
  v_and_or_b32 v230, v0, 60, s79
  s_waitcnt lgkmcnt(0)
  v_readfirstlane_b32 s30, v248
  v_readfirstlane_b32 s31, v249
  v_mov_b32 v224, 0
  v_mov_b32 v225, 0
  s_bfe_u32 s64, s30, 0x10000
  s_lshl_b32 s64, s64, 12
  s_xor_b32 s44, s64, s65
  s_bfe_u32 s64, s30, 0x10001
  s_lshl_b32 s64, s64, 16
  s_xor_b32 s44, s64, s44
  s_bfe_u32 s64, s30, 0x10002
  s_lshl_b32 s64, s64, 15
  s_xor_b32 s44, s64, s44
  s_bfe_u32 s64, s30, 0x40003
  s_lshl_b32 s64, s64, 17
  s_xor_b32 s44, s64, s44
  s_add_u32 s67, s44, 8192
  s_bitcmp1_b32 s30, 7
  s_cselect_b64 s[48:49], s[52:53], s[54:55]
  s_lshl_b32 s77, s30, 6
  s_add_u32 s77, s77, 139264
  s_mov_b64 exec, 1
  ds_add_rtn_u64 v[248:249], v251, v[250:251] offset:560
  s_mov_b64 exec, -1
  s_waitcnt vmcnt(38)
  v_dot2c_f32_bf16 v224, v32, v24
  v_dot2c_f32_bf16 v224, v33, v25
  v_dot2c_f32_bf16 v224, v34, v26
  v_dot2c_f32_bf16 v224, v35, v27
  v_dot2c_f32_bf16 v224, v36, v28
  v_dot2c_f32_bf16 v224, v37, v29
  v_dot2c_f32_bf16 v224, v38, v30
  v_dot2c_f32_bf16 v224, v39, v31
  buffer_load_dwordx4 v[32:35], v4, s[48:51], s44 offen offset:0 nt
  buffer_load_dwordx4 v[36:39], v4, s[48:51], s44 offen offset:256 nt
  s_waitcnt vmcnt(38)
  v_dot2c_f32_bf16 v225, v40, v24
  v_dot2c_f32_bf16 v225, v41, v25
  v_dot2c_f32_bf16 v225, v42, v26
  v_dot2c_f32_bf16 v225, v43, v27
  v_dot2c_f32_bf16 v225, v44, v28
  v_dot2c_f32_bf16 v225, v45, v29
  v_dot2c_f32_bf16 v225, v46, v30
  v_dot2c_f32_bf16 v225, v47, v31
  buffer_load_dwordx4 v[40:43], v4, s[48:51], s67 offen offset:0 nt
  buffer_load_dwordx4 v[44:47], v4, s[48:51], s67 offen offset:256 nt
  v_add_f32_dpp v226, v224, v224 row_ror:8 bank_mask:0x3
  v_add_f32_dpp v226, v225, v225 row_ror:8 bank_mask:0xc
  v_mov_b32 v224, 0
  v_mov_b32 v225, 0
  v_add_f32_dpp v226, v226, v226 row_half_mirror bank_mask:0x5
  s_waitcnt vmcnt(38)
  v_dot2c_f32_bf16 v224, v48, v24
  v_dot2c_f32_bf16 v224, v49, v25
  v_dot2c_f32_bf16 v224, v50, v26
  v_dot2c_f32_bf16 v224, v51, v27
  v_dot2c_f32_bf16 v224, v52, v28
  v_dot2c_f32_bf16 v224, v53, v29
  v_dot2c_f32_bf16 v224, v54, v30
  v_dot2c_f32_bf16 v224, v55, v31
  buffer_load_dwordx4 v[48:51], v4, s[48:51], s44 offen offset:2048 nt
  buffer_load_dwordx4 v[52:55], v4, s[48:51], s44 offen offset:2304 nt
  s_waitcnt vmcnt(38)
  v_dot2c_f32_bf16 v225, v56, v24
  v_dot2c_f32_bf16 v225, v57, v25
  v_dot2c_f32_bf16 v225, v58, v26
  v_dot2c_f32_bf16 v225, v59, v27
  v_dot2c_f32_bf16 v225, v60, v28
  v_dot2c_f32_bf16 v225, v61, v29
  v_dot2c_f32_bf16 v225, v62, v30
  v_dot2c_f32_bf16 v225, v63, v31
  buffer_load_dwordx4 v[56:59], v4, s[48:51], s67 offen offset:2048 nt
  buffer_load_dwordx4 v[60:63], v4, s[48:51], s67 offen offset:2304 nt
  v_add_f32_dpp v227, v224, v224 row_ror:8 bank_mask:0x3
  v_add_f32_dpp v227, v225, v225 row_ror:8 bank_mask:0xc
  s_nop 1
  v_add_f32_dpp v226, v227, v227 row_half_mirror bank_mask:0xa
  s_nop 1
  v_add_f32_dpp v226, v226, v226 quad_perm:[1,0,3,2]
  s_nop 1
  v_add_f32_dpp v226, v226, v226 quad_perm:[2,3,0,1]
  v_cvt_pk_bf16_f32 v226, v251, v226
  ds_write_b32 v230, v226 offset:8192
  v_and_or_b32 v230, v0, 60, s79
  s_waitcnt lgkmcnt(0)
  v_readfirstlane_b32 s30, v248
  v_readfirstlane_b32 s31, v249
  v_mov_b32 v224, 0
  v_mov_b32 v225, 0
  s_bfe_u32 s64, s30, 0x10000
  s_lshl_b32 s64, s64, 12
  s_xor_b32 s44, s64, s65
  s_bfe_u32 s64, s30, 0x10001
  s_lshl_b32 s64, s64, 16
  s_xor_b32 s44, s64, s44
  s_bfe_u32 s64, s30, 0x10002
  s_lshl_b32 s64, s64, 15
  s_xor_b32 s44, s64, s44
  s_bfe_u32 s64, s30, 0x40003
  s_lshl_b32 s64, s64, 17
  s_xor_b32 s44, s64, s44
  s_add_u32 s67, s44, 8192
  s_bitcmp1_b32 s30, 7
  s_cselect_b64 s[48:49], s[52:53], s[54:55]
  s_lshl_b32 s78, s30, 6
  s_add_u32 s78, s78, 139264
  s_mov_b64 exec, 1
  ds_add_rtn_u64 v[248:249], v251, v[250:251] offset:560
  s_mov_b64 exec, -1
  s_waitcnt vmcnt(38)
  v_dot2c_f32_bf16 v224, v64, v24
  v_dot2c_f32_bf16 v224, v65, v25
  v_dot2c_f32_bf16 v224, v66, v26
  v_dot2c_f32_bf16 v224, v67, v27
  v_dot2c_f32_bf16 v224, v68, v28
  v_dot2c_f32_bf16 v224, v69, v29
  v_dot2c_f32_bf16 v224, v70, v30
  v_dot2c_f32_bf16 v224, v71, v31
  buffer_load_dwordx4 v[64:67], v4, s[48:51], s44 offen offset:0 nt
  buffer_load_dwordx4 v[68:71], v4, s[48:51], s44 offen offset:256 nt
  s_waitcnt vmcnt(38)
  v_dot2c_f32_bf16 v225, v72, v24
  v_dot2c_f32_bf16 v225, v73, v25
  v_dot2c_f32_bf16 v225, v74, v26
  v_dot2c_f32_bf16 v225, v75, v27
  v_dot2c_f32_bf16 v225, v76, v28
  v_dot2c_f32_bf16 v225, v77, v29
  v_dot2c_f32_bf16 v225, v78, v30
  v_dot2c_f32_bf16 v225, v79, v31
  buffer_load_dwordx4 v[72:75], v4, s[48:51], s67 offen offset:0 nt
  buffer_load_dwordx4 v[76:79], v4, s[48:51], s67 offen offset:256 nt
  v_add_f32_dpp v226, v224, v224 row_ror:8 bank_mask:0x3
  v_add_f32_dpp v226, v225, v225 row_ror:8 bank_mask:0xc
  v_mov_b32 v224, 0
  v_mov_b32 v225, 0
  v_add_f32_dpp v226, v226, v226 row_half_mirror bank_mask:0x5
  s_waitcnt vmcnt(38)
  v_dot2c_f32_bf16 v224, v80, v24
  v_dot2c_f32_bf16 v224, v81, v25
  v_dot2c_f32_bf16 v224, v82, v26
  v_dot2c_f32_bf16 v224, v83, v27
  v_dot2c_f32_bf16 v224, v84, v28
  v_dot2c_f32_bf16 v224, v85, v29
  v_dot2c_f32_bf16 v224, v86, v30
  v_dot2c_f32_bf16 v224, v87, v31
  buffer_load_dwordx4 v[80:83], v4, s[48:51], s44 offen offset:2048 nt
  buffer_load_dwordx4 v[84:87], v4, s[48:51], s44 offen offset:2304 nt
  s_waitcnt vmcnt(38)
  v_dot2c_f32_bf16 v225, v88, v24
  v_dot2c_f32_bf16 v225, v89, v25
  v_dot2c_f32_bf16 v225, v90, v26
  v_dot2c_f32_bf16 v225, v91, v27
  v_dot2c_f32_bf16 v225, v92, v28
  v_dot2c_f32_bf16 v225, v93, v29
  v_dot2c_f32_bf16 v225, v94, v30
  v_dot2c_f32_bf16 v225, v95, v31
  buffer_load_dwordx4 v[88:91], v4, s[48:51], s67 offen offset:2048 nt
  buffer_load_dwordx4 v[92:95], v4, s[48:51], s67 offen offset:2304 nt
  v_add_f32_dpp v227, v224, v224 row_ror:8 bank_mask:0x3
  v_add_f32_dpp v227, v225, v225 row_ror:8 bank_mask:0xc
  s_nop 1
  v_add_f32_dpp v226, v227, v227 row_half_mirror bank_mask:0xa
  s_nop 1
  v_add_f32_dpp v226, v226, v226 quad_perm:[1,0,3,2]
  s_nop 1
  v_add_f32_dpp v226, v226, v226 quad_perm:[2,3,0,1]
  v_cvt_pk_bf16_f32 v226, v251, v226
  ds_write_b32 v230, v226 offset:8448
  v_and_or_b32 v230, v0, 60, s79
  v_mov_b32 v224, 0
  v_mov_b32 v225, 0
  s_waitcnt vmcnt(38)
  v_dot2c_f32_bf16 v224, v96, v24
  v_dot2c_f32_bf16 v224, v97, v25
  v_dot2c_f32_bf16 v224, v98, v26
  v_dot2c_f32_bf16 v224, v99, v27
  v_dot2c_f32_bf16 v224, v100, v28
  v_dot2c_f32_bf16 v224, v101, v29
  v_dot2c_f32_bf16 v224, v102, v30
  v_dot2c_f32_bf16 v224, v103, v31
  s_waitcnt vmcnt(36)
  v_dot2c_f32_bf16 v225, v104, v24
  v_dot2c_f32_bf16 v225, v105, v25
  v_dot2c_f32_bf16 v225, v106, v26
  v_dot2c_f32_bf16 v225, v107, v27
  v_dot2c_f32_bf16 v225, v108, v28
  v_dot2c_f32_bf16 v225, v109, v29
  v_dot2c_f32_bf16 v225, v110, v30
  v_dot2c_f32_bf16 v225, v111, v31
  s_nop 1
  v_add_f32_dpp v226, v224, v224 row_ror:8 bank_mask:0x3
  v_add_f32_dpp v226, v225, v225 row_ror:8 bank_mask:0xc
  v_mov_b32 v224, 0
  v_mov_b32 v225, 0
  v_add_f32_dpp v226, v226, v226 row_half_mirror bank_mask:0x5
  s_waitcnt vmcnt(34)
  v_dot2c_f32_bf16 v224, v112, v24
  v_dot2c_f32_bf16 v224, v113, v25
  v_dot2c_f32_bf16 v224, v114, v26
  v_dot2c_f32_bf16 v224, v115, v27
  v_dot2c_f32_bf16 v224, v116, v28
  v_dot2c_f32_bf16 v224, v117, v29
  v_dot2c_f32_bf16 v224, v118, v30
  v_dot2c_f32_bf16 v224, v119, v31
  s_waitcnt vmcnt(32)
  v_dot2c_f32_bf16 v225, v120, v24
  v_dot2c_f32_bf16 v225, v121, v25
  v_dot2c_f32_bf16 v225, v122, v26
  v_dot2c_f32_bf16 v225, v123, v27
  v_dot2c_f32_bf16 v225, v124, v28
  v_dot2c_f32_bf16 v225, v125, v29
  v_dot2c_f32_bf16 v225, v126, v30
  v_dot2c_f32_bf16 v225, v127, v31
  s_nop 1
  v_add_f32_dpp v227, v224, v224 row_ror:8 bank_mask:0x3
  v_add_f32_dpp v227, v225, v225 row_ror:8 bank_mask:0xc
  s_nop 1
  v_add_f32_dpp v226, v227, v227 row_half_mirror bank_mask:0xa
  s_nop 1
  v_add_f32_dpp v226, v226, v226 quad_perm:[1,0,3,2]
  s_nop 1
  v_add_f32_dpp v226, v226, v226 quad_perm:[2,3,0,1]
  v_cvt_pk_bf16_f32 v226, v251, v226
  ds_write_b32 v230, v226 offset:8704
  v_and_or_b32 v230, v0, 60, s79
  v_mov_b32 v224, 0
  v_mov_b32 v225, 0
  s_waitcnt vmcnt(30)
  v_dot2c_f32_bf16 v224, v128, v24
  v_dot2c_f32_bf16 v224, v129, v25
  v_dot2c_f32_bf16 v224, v130, v26
  v_dot2c_f32_bf16 v224, v131, v27
  v_dot2c_f32_bf16 v224, v132, v28
  v_dot2c_f32_bf16 v224, v133, v29
  v_dot2c_f32_bf16 v224, v134, v30
  v_dot2c_f32_bf16 v224, v135, v31
  s_waitcnt vmcnt(28)
  v_dot2c_f32_bf16 v225, v136, v24
  v_dot2c_f32_bf16 v225, v137, v25
  v_dot2c_f32_bf16 v225, v138, v26
  v_dot2c_f32_bf16 v225, v139, v27
  v_dot2c_f32_bf16 v225, v140, v28
  v_dot2c_f32_bf16 v225, v141, v29
  v_dot2c_f32_bf16 v225, v142, v30
  v_dot2c_f32_bf16 v225, v143, v31
  s_nop 1
  v_add_f32_dpp v226, v224, v224 row_ror:8 bank_mask:0x3
  v_add_f32_dpp v226, v225, v225 row_ror:8 bank_mask:0xc
  v_mov_b32 v224, 0
  v_mov_b32 v225, 0
  v_add_f32_dpp v226, v226, v226 row_half_mirror bank_mask:0x5
  s_waitcnt vmcnt(26)
  v_dot2c_f32_bf16 v224, v144, v24
  v_dot2c_f32_bf16 v224, v145, v25
  v_dot2c_f32_bf16 v224, v146, v26
  v_dot2c_f32_bf16 v224, v147, v27
  v_dot2c_f32_bf16 v224, v148, v28
  v_dot2c_f32_bf16 v224, v149, v29
  v_dot2c_f32_bf16 v224, v150, v30
  v_dot2c_f32_bf16 v224, v151, v31
  s_waitcnt vmcnt(24)
  v_dot2c_f32_bf16 v225, v152, v24
  v_dot2c_f32_bf16 v225, v153, v25
  v_dot2c_f32_bf16 v225, v154, v26
  v_dot2c_f32_bf16 v225, v155, v27
  v_dot2c_f32_bf16 v225, v156, v28
  v_dot2c_f32_bf16 v225, v157, v29
  v_dot2c_f32_bf16 v225, v158, v30
  v_dot2c_f32_bf16 v225, v159, v31
  s_nop 1
  v_add_f32_dpp v227, v224, v224 row_ror:8 bank_mask:0x3
  v_add_f32_dpp v227, v225, v225 row_ror:8 bank_mask:0xc
  s_nop 1
  v_add_f32_dpp v226, v227, v227 row_half_mirror bank_mask:0xa
  s_nop 1
  v_add_f32_dpp v226, v226, v226 quad_perm:[1,0,3,2]
  s_nop 1
  v_add_f32_dpp v226, v226, v226 quad_perm:[2,3,0,1]
  v_cvt_pk_bf16_f32 v226, v251, v226
  ds_write_b32 v230, v226 offset:8960
  v_and_or_b32 v230, v0, 60, s79
  v_mov_b32 v224, 0
  v_mov_b32 v225, 0
  s_waitcnt vmcnt(22)
  v_dot2c_f32_bf16 v224, v160, v24
  v_dot2c_f32_bf16 v224, v161, v25
  v_dot2c_f32_bf16 v224, v162, v26
  v_dot2c_f32_bf16 v224, v163, v27
  v_dot2c_f32_bf16 v224, v164, v28
  v_dot2c_f32_bf16 v224, v165, v29
  v_dot2c_f32_bf16 v224, v166, v30
  v_dot2c_f32_bf16 v224, v167, v31
  s_waitcnt vmcnt(20)
  v_dot2c_f32_bf16 v225, v168, v24
  v_dot2c_f32_bf16 v225, v169, v25
  v_dot2c_f32_bf16 v225, v170, v26
  v_dot2c_f32_bf16 v225, v171, v27
  v_dot2c_f32_bf16 v225, v172, v28
  v_dot2c_f32_bf16 v225, v173, v29
  v_dot2c_f32_bf16 v225, v174, v30
  v_dot2c_f32_bf16 v225, v175, v31
  s_nop 1
  v_add_f32_dpp v226, v224, v224 row_ror:8 bank_mask:0x3
  v_add_f32_dpp v226, v225, v225 row_ror:8 bank_mask:0xc
  v_mov_b32 v224, 0
  v_mov_b32 v225, 0
  v_add_f32_dpp v226, v226, v226 row_half_mirror bank_mask:0x5
  s_waitcnt vmcnt(18)
  v_dot2c_f32_bf16 v224, v176, v24
  v_dot2c_f32_bf16 v224, v177, v25
  v_dot2c_f32_bf16 v224, v178, v26
  v_dot2c_f32_bf16 v224, v179, v27
  v_dot2c_f32_bf16 v224, v180, v28
  v_dot2c_f32_bf16 v224, v181, v29
  v_dot2c_f32_bf16 v224, v182, v30
  v_dot2c_f32_bf16 v224, v183, v31
  s_waitcnt vmcnt(16)
  v_dot2c_f32_bf16 v225, v184, v24
  v_dot2c_f32_bf16 v225, v185, v25
  v_dot2c_f32_bf16 v225, v186, v26
  v_dot2c_f32_bf16 v225, v187, v27
  v_dot2c_f32_bf16 v225, v188, v28
  v_dot2c_f32_bf16 v225, v189, v29
  v_dot2c_f32_bf16 v225, v190, v30
  v_dot2c_f32_bf16 v225, v191, v31
  s_nop 1
  v_add_f32_dpp v227, v224, v224 row_ror:8 bank_mask:0x3
  v_add_f32_dpp v227, v225, v225 row_ror:8 bank_mask:0xc
  s_nop 1
  v_add_f32_dpp v226, v227, v227 row_half_mirror bank_mask:0xa
  s_nop 1
  v_add_f32_dpp v226, v226, v226 quad_perm:[1,0,3,2]
  s_nop 1
  v_add_f32_dpp v226, v226, v226 quad_perm:[2,3,0,1]
  v_cvt_pk_bf16_f32 v226, v251, v226
  ds_write_b32 v230, v226 offset:9216
L_k0:
  s_cmp_ge_u32 s77, 147456
  s_cbranch_scc1 L_tr0
  v_and_or_b32 v230, v0, 60, s77
  s_waitcnt lgkmcnt(0)
  v_readfirstlane_b32 s30, v248
  v_readfirstlane_b32 s31, v249
  v_mov_b32 v224, 0
  v_mov_b32 v225, 0
  s_lshr_b32 s70, s31, 16
  s_and_b32 s31, s31, 0xffff
  s_cmp_lt_u32 s30, s70
  s_cselect_b32 s68, 1, 0
  s_add_u32 s70, s70, 3
  s_cmp_lt_u32 s30, s70
  s_addc_u32 s68, s68, 0
  s_add_u32 s69, s30, 10
  s_cmp_ge_u32 s69, s31
  s_cselect_b32 s68, 3, s68
  s_cmp_lt_u32 s30, s31
  s_cbranch_scc0 L_fink0
  s_bfe_u32 s64, s30, 0x10000
  s_lshl_b32 s64, s64, 12
  s_xor_b32 s44, s64, s65
  s_bfe_u32 s64, s30, 0x10001
  s_lshl_b32 s64, s64, 16
  s_xor_b32 s44, s64, s44
  s_bfe_u32 s64, s30, 0x10002
  s_lshl_b32 s64, s64, 15
  s_xor_b32 s44, s64, s44
  s_bfe_u32 s64, s30, 0x40003
  s_lshl_b32 s64, s64, 17
  s_xor_b32 s44, s64, s44
  s_add_u32 s67, s44, 8192
  s_bitcmp1_b32 s30, 7
  s_cselect_b64 s[48:49], s[52:53], s[54:55]
  s_lshl_b32 s77, s30, 6
  s_add_u32 s77, s77, 139264
  s_mov_b64 exec, 1
  ds_add_rtn_u64 v[248:249], v251, v[250:251] offset:560
  s_mov_b64 exec, -1
L_gok0:
  s_cmp_ge_u32 s68, 3
  s_cbranch_scc1 L_tk00_3
  s_cmp_ge_u32 s68, 2
  s_cbranch_scc1 L_tk00_2
  s_cmp_ge_u32 s68, 1
  s_cbranch_scc1 L_tk00_1
  s_waitcnt vmcnt(0)
L_tk00_1:
  s_waitcnt vmcnt(2)
L_tk00_2:
  s_waitcnt vmcnt(4)
L_tk00_3:
  s_waitcnt vmcnt(14)
  v_dot2c_f32_bf16 v224, v32, v24
  v_dot2c_f32_bf16 v224, v33, v25
  v_dot2c_f32_bf16 v224, v34, v26
  v_dot2c_f32_bf16 v224, v35, v27
  v_dot2c_f32_bf16 v224, v36, v28
  v_dot2c_f32_bf16 v224, v37, v29
  v_dot2c_f32_bf16 v224, v38, v30
  v_dot2c_f32_bf16 v224, v39, v31
  buffer_load_dwordx4 v[32:35], v4, s[48:51], s44 offen offset:0 nt
  buffer_load_dwordx4 v[36:39], v4, s[48:51], s44 offen offset:256 nt
  s_waitcnt vmcnt(14)
  v_dot2c_f32_bf16 v225, v40, v24
  v_dot2c_f32_bf16 v225, v41, v25
  v_dot2c_f32_bf16 v225, v42, v26
  v_dot2c_f32_bf16 v225, v43, v27
  v_dot2c_f32_bf16 v225, v44, v28
  v_dot2c_f32_bf16 v225, v45, v29
  v_dot2c_f32_bf16 v225, v46, v30
  v_dot2c_f32_bf16 v225, v47, v31
  buffer_load_dwordx4 v[40:43], v4, s[48:51], s67 offen offset:0 nt
  buffer_load_dwordx4 v[44:47], v4, s[48:51], s67 offen offset:256 nt
  v_add_f32_dpp v226, v224, v224 row_ror:8 bank_mask:0x3
  v_add_f32_dpp v226, v225, v225 row_ror:8 bank_mask:0xc
  v_mov_b32 v224, 0
  v_mov_b32 v225, 0
  v_add_f32_dpp v226, v226, v226 row_half_mirror bank_mask:0x5
  s_cmp_ge_u32 s68, 3
  s_cbranch_scc1 L_tk01_3
  s_cmp_ge_u32 s68, 2
  s_cbranch_scc1 L_tk01_2
  s_cmp_ge_u32 s68, 1
  s_cbranch_scc1 L_tk01_1
  s_waitcnt vmcnt(0)
L_tk01_1:
  s_waitcnt vmcnt(2)
L_tk01_2:
  s_waitcnt vmcnt(4)
L_tk01_3:
  s_waitcnt vmcnt(14)
  v_dot2c_f32_bf16 v224, v48, v24
  v_dot2c_f32_bf16 v224, v49, v25
  v_dot2c_f32_bf16 v224, v50, v26
  v_dot2c_f32_bf16 v224, v51, v27
  v_dot2c_f32_bf16 v224, v52, v28
  v_dot2c_f32_bf16 v224, v53, v29
  v_dot2c_f32_bf16 v224, v54, v30
  v_dot2c_f32_bf16 v224, v55, v31
  buffer_load_dwordx4 v[48:51], v4, s[48:51], s44 offen offset:2048 nt
  buffer_load_dwordx4 v[52:55], v4, s[48:51], s44 offen offset:2304 nt
  s_waitcnt vmcnt(14)
  v_dot2c_f32_bf16 v225, v56, v24
  v_dot2c_f32_bf16 v225, v57, v25
  v_dot2c_f32_bf16 v225, v58, v26
  v_dot2c_f32_bf16 v225, v59, v27
  v_dot2c_f32_bf16 v225, v60, v28
  v_dot2c_f32_bf16 v225, v61, v29
  v_dot2c_f32_bf16 v225, v62, v30
  v_dot2c_f32_bf16 v225, v63, v31
  buffer_load_dwordx4 v[56:59], v4, s[48:51], s67 offen offset:2048 nt
  buffer_load_dwordx4 v[60:63], v4, s[48:51], s67 offen offset:2304 nt
  v_add_f32_dpp v227, v224, v224 row_ror:8 bank_mask:0x3
  v_add_f32_dpp v227, v225, v225 row_ror:8 bank_mask:0xc
  s_nop 1
  v_add_f32_dpp v226, v227, v227 row_half_mirror bank_mask:0xa
  s_nop 1
  v_add_f32_dpp v226, v226, v226 quad_perm:[1,0,3,2]
  s_nop 1
  v_add_f32_dpp v226, v226, v226 quad_perm:[2,3,0,1]
  v_cvt_pk_bf16_f32 v226, v251, v226
  ds_write_b32 v230, v226 offset:8192
  s_cmp_eq_u32 s46, 0
  s_cbranch_scc1 L_sdone
L_k1:
  s_cmp_ge_u32 s78, 147456
  s_cbranch_scc1 L_tr1
  v_and_or_b32 v230, v0, 60, s78
  s_waitcnt lgkmcnt(0)
  v_readfirstlane_b32 s30, v248
  v_readfirstlane_b32 s31, v249
  v_mov_b32 v224, 0
  v_mov_b32 v225, 0
  s_lshr_b32 s70, s31, 16
  s_and_b32 s31, s31, 0xffff
  s_cmp_lt_u32 s30, s70
  s_cselect_b32 s68, 1, 0
  s_add_u32 s70, s70, 3
  s_cmp_lt_u32 s30, s70
  s_addc_u32 s68, s68, 0
  s_add_u32 s69, s30, 10
  s_cmp_ge_u32 s69, s31
  s_cselect_b32 s68, 3, s68
  s_cmp_lt_u32 s30, s31
  s_cbranch_scc0 L_fink1
  s_bfe_u32 s64, s30, 0x10000
  s_lshl_b32 s64, s64, 12
  s_xor_b32 s44, s64, s65
  s_bfe_u32 s64, s30, 0x10001
  s_lshl_b32 s64, s64, 16
  s_xor_b32 s44, s64, s44
  s_bfe_u32 s64, s30, 0x10002
  s_lshl_b32 s64, s64, 15
  s_xor_b32 s44, s64, s44
  s_bfe_u32 s64, s30, 0x40003
  s_lshl_b32 s64, s64, 17
  s_xor_b32 s44, s64, s44
  s_add_u32 s67, s44, 8192
  s_bitcmp1_b32 s30, 7
  s_cselect_b64 s[48:49], s[52:53], s[54:55]
  s_lshl_b32 s78, s30, 6
  s_add_u32 s78, s78, 139264
  s_mov_b64 exec, 1
  ds_add_rtn_u64 v[248:249], v251, v[250:251] offset:560
  s_mov_b64 exec, -1
L_gok1:
  s_cmp_ge_u32 s68, 3
  s_cbranch_scc1 L_tk10_3
  s_cmp_ge_u32 s68, 2
  s_cbranch_scc1 L_tk10_2
  s_cmp_ge_u32 s68, 1
  s_cbranch_scc1 L_tk10_1
  s_waitcnt vmcnt(0)
L_tk10_1:
  s_waitcnt vmcnt(2)
L_tk10_2:
  s_waitcnt vmcnt(4)
L_tk10_3:
  s_waitcnt vmcnt(14)
  v_dot2c_f32_bf16 v224, v64, v24
  v_dot2c_f32_bf16 v224, v65, v25
  v_dot2c_f32_bf16 v224, v66, v26
  v_dot2c_f32_bf16 v224, v67, v27
  v_dot2c_f32_bf16 v224, v68, v28
  v_dot2c_f32_bf16 v224, v69, v29
  v_dot2c_f32_bf16 v224, v70, v30
  v_dot2c_f32_bf16 v224, v71, v31
  buffer_load_dwordx4 v[64:67], v4, s[48:51], s44 offen offset:0 nt
  buffer_load_dwordx4 v[68:71], v4, s[48:51], s44 offen offset:256 nt
  s_waitcnt vmcnt(14)
  v_dot2c_f32_bf16 v225, v72, v24
  v_dot2c_f32_bf16 v225, v73, v25
  v_dot2c_f32_bf16 v225, v74, v26
  v_dot2c_f32_bf16 v225, v75, v27
  v_dot2c_f32_bf16 v225, v76, v28
  v_dot2c_f32_bf16 v225, v77, v29
  v_dot2c_f32_bf16 v225, v78, v30
  v_dot2c_f32_bf16 v225, v79, v31
  buffer_load_dwordx4 v[72:75], v4, s[48:51], s67 offen offset:0 nt
  buffer_load_dwordx4 v[76:79], v4, s[48:51], s67 offen offset:256 nt
  v_add_f32_dpp v226, v224, v224 row_ror:8 bank_mask:0x3
  v_add_f32_dpp v226, v225, v225 row_ror:8 bank_mask:0xc
  v_mov_b32 v224, 0
  v_mov_b32 v225, 0
  v_add_f32_dpp v226, v226, v226 row_half_mirror bank_mask:0x5
  s_cmp_ge_u32 s68, 3
  s_cbranch_scc1 L_tk11_3
  s_cmp_ge_u32 s68, 2
  s_cbranch_scc1 L_tk11_2
  s_cmp_ge_u32 s68, 1
  s_cbranch_scc1 L_tk11_1
  s_waitcnt vmcnt(0)
L_tk11_1:
  s_waitcnt vmcnt(2)
L_tk11_2:
  s_waitcnt vmcnt(4)
L_tk11_3:
  s_waitcnt vmcnt(14)
  v_dot2c_f32_bf16 v224, v80, v24
  v_dot2c_f32_bf16 v224, v81, v25
  v_dot2c_f32_bf16 v224, v82, v26
  v_dot2c_f32_bf16 v224, v83, v27
  v_dot2c_f32_bf16 v224, v84, v28
  v_dot2c_f32_bf16 v224, v85, v29
  v_dot2c_f32_bf16 v224, v86, v30
  v_dot2c_f32_bf16 v224, v87, v31
  buffer_load_dwordx4 v[80:83], v4, s[48:51], s44 offen offset:2048 nt
  buffer_load_dwordx4 v[84:87], v4, s[48:51], s44 offen offset:2304 nt
  s_waitcnt vmcnt(14)
  v_dot2c_f32_bf16 v225, v88, v24
  v_dot2c_f32_bf16 v225, v89, v25
  v_dot2c_f32_bf16 v225, v90, v26
  v_dot2c_f32_bf16 v225, v91, v27
  v_dot2c_f32_bf16 v225, v92, v28
  v_dot2c_f32_bf16 v225, v93, v29
  v_dot2c_f32_bf16 v225, v94, v30
  v_dot2c_f32_bf16 v225, v95, v31
  buffer_load_dwordx4 v[88:91], v4, s[48:51], s67 offen offset:2048 nt
  buffer_load_dwordx4 v[92:95], v4, s[48:51], s67 offen offset:2304 nt
  v_add_f32_dpp v227, v224, v224 row_ror:8 bank_mask:0x3
  v_add_f32_dpp v227, v225, v225 row_ror:8 bank_mask:0xc
  s_nop 1
  v_add_f32_dpp v226, v227, v227 row_half_mirror bank_mask:0xa
  s_nop 1
  v_add_f32_dpp v226, v226, v226 quad_perm:[1,0,3,2]
  s_nop 1
  v_add_f32_dpp v226, v226, v226 quad_perm:[2,3,0,1]
  v_cvt_pk_bf16_f32 v226, v251, v226
  ds_write_b32 v230, v226 offset:8192
  s_cmp_eq_u32 s46, 0
  s_cbranch_scc1 L_sdone
  s_branch L_k0
L_v0:
  s_waitcnt lgkmcnt(0)
  v_readfirstlane_b32 s30, v248
  v_readfirstlane_b32 s31, v249
  v_cmp_ne_u16 vcc, 0, v226
  s_cbranch_vccnz L_rt0
  s_cmp_ge_u32 s30, s71
  s_cbranch_scc1 L_wld
L_wldx:
  s_lshr_b32 s70, s31, 16
  s_and_b32 s31, s31, 0xffff
  s_cmp_lt_u32 s30, s70
  s_cselect_b32 s68, 1, 0
  s_add_u32 s70, s70, 3
  s_cmp_lt_u32 s30, s70
  s_addc_u32 s68, s68, 0
  s_add_u32 s69, s30, 10
  s_cmp_ge_u32 s69, s31
  s_cselect_b32 s68, 3, s68
  s_cmp_lt_u32 s30, s31
  s_cbranch_scc0 L_finv0
  s_bfe_u32 s64, s30, 0x10000
  s_lshl_b32 s64, s64, 12
  s_xor_b32 s44, s64, s65
  s_bfe_u32 s64, s30, 0x10001
  s_lshl_b32 s64, s64, 16
  s_xor_b32 s44, s64, s44
  s_bfe_u32 s64, s30, 0x10002
  s_lshl_b32 s64, s64, 15
  s_xor_b32 s44, s64, s44
  s_bfe_u32 s64, s30, 0x40003
  s_lshl_b32 s64, s64, 17
  s_xor_b32 s44, s64, s44
  s_add_u32 s67, s44, 8192
  s_lshl_b32 s77, s30, 6
  s_add_u32 s77, s77, 139264
  s_mov_b64 exec, 1
  ds_add_rtn_u64 v[248:249], v251, v[250:251] offset:560
  s_mov_b64 exec, -1
L_gov0:
  v_max_f32_dpp v227, v226, v226 row_ror:8
  s_nop 1
  v_max_f32_dpp v227, v227, v227 row_ror:4
  v_max_f32 v227, s61, v227
  s_nop 1
  v_max_f32_dpp v227, v227, v227 row_bcast:15 row_mask:0xa
  s_nop 1
  v_max_f32_dpp v227, v227, v227 row_bcast:31 row_mask:0xc
  s_nop 0
  v_readlane_b32 s61, v227, 63
  v_and_or_b32 v227, v0, 60, s78
  s_nop 0
  v_mul_f32 v228, s61, v235
  v_sub_f32 v230, v228, v229
  v_fma_f32 v231, v226, v234, v228
  ds_read_b32 v226, v227
  v_exp_f32 v230, v230
  v_exp_f32 v231, v231
  v_mul_f32 v16, v230, v16
  v_cvt_pk_bf16_f32 v232, v231, v231
  v_mul_f32 v17, v230, v17
  v_mul_f32 v20, v230, v20
  v_and_b32_dpp v8, v232, v1 row_newbcast:0 bank_mask:0x1
  v_and_b32_dpp v9, v232, v1 row_newbcast:0 bank_mask:0x2
  v_and_b32_dpp v10, v232, v1 row_newbcast:0 bank_mask:0x4
  v_and_b32_dpp v11, v232, v1 row_newbcast:0 bank_mask:0x8
  v_mul_f32 v21, v230, v21
  v_fma_f32 v233, v233, v230, v231
  v_and_b32_dpp v12, v232, v1 row_newbcast:8 bank_mask:0x1
  v_and_b32_dpp v13, v232, v1 row_newbcast:8 bank_mask:0x2
  v_and_b32_dpp v14, v232, v1 row_newbcast:8 bank_mask:0x4
  v_and_b32_dpp v15, v232, v1 row_newbcast:8 bank_mask:0x8
  v_and_b32_dpp v24, v232, v1 row_newbcast:4 bank_mask:0x1
  v_and_b32_dpp v25, v232, v1 row_newbcast:4 bank_mask:0x2
  v_and_b32_dpp v26, v232, v1 row_newbcast:4 bank_mask:0x4
  v_and_b32_dpp v27, v232, v1 row_newbcast:4 bank_mask:0x8
  v_and_b32_dpp v28, v232, v1 row_newbcast:12 bank_mask:0x1
  v_and_b32_dpp v29, v232, v1 row_newbcast:12 bank_mask:0x2
  v_and_b32_dpp v30, v232, v1 row_newbcast:12 bank_mask:0x4
  v_and_b32_dpp v31, v232, v1 row_newbcast:12 bank_mask:0x8
  s_cmp_ge_u32 s68, 3
  s_cbranch_scc1 L_tv00_3
  s_cmp_ge_u32 s68, 2
  s_cbranch_scc1 L_tv00_2
  s_cmp_ge_u32 s68, 1
  s_cbranch_scc1 L_tv00_1
  s_waitcnt vmcnt(0)
L_tv00_1:
  s_waitcnt vmcnt(2)
L_tv00_2:
  s_waitcnt vmcnt(4)
L_tv00_3:
  s_waitcnt vmcnt(14)
  v_mfma_f32_16x16x32_bf16 v[16:19], v[8:11], v[32:35], v[16:19]
  v_mfma_f32_16x16x32_bf16 v[20:23], v[8:11], v[36:39], v[20:23]
  buffer_load_dwordx4 v[32:35], v4, s[48:51], s44 offen offset:0 nt
  buffer_load_dwordx4 v[36:39], v4, s[48:51], s44 offen offset:256 nt
  s_waitcnt vmcnt(14)
  v_mfma_f32_16x16x32_bf16 v[16:19], v[12:15], v[40:43], v[16:19]
  v_mfma_f32_16x16x32_bf16 v[20:23], v[12:15], v[44:47], v[20:23]
  buffer_load_dwordx4 v[40:43], v4, s[48:51], s67 offen offset:0 nt
  buffer_load_dwordx4 v[44:47], v4, s[48:51], s67 offen offset:256 nt
  s_cmp_ge_u32 s68, 3
  s_cbranch_scc1 L_tv02_3
  s_cmp_ge_u32 s68, 2
  s_cbranch_scc1 L_tv02_2
  s_cmp_ge_u32 s68, 1
  s_cbranch_scc1 L_tv02_1
  s_waitcnt vmcnt(0)
L_tv02_1:
  s_waitcnt vmcnt(2)
L_tv02_2:
  s_waitcnt vmcnt(4)
L_tv02_3:
  s_waitcnt vmcnt(14)
  v_mfma_f32_16x16x32_bf16 v[16:19], v[24:27], v[48:51], v[16:19]
  v_mfma_f32_16x16x32_bf16 v[20:23], v[24:27], v[52:55], v[20:23]
  buffer_load_dwordx4 v[48:51], v4, s[48:51], s44 offen offset:2048 nt
  buffer_load_dwordx4 v[52:55], v4, s[48:51], s44 offen offset:2304 nt
  s_waitcnt vmcnt(14)
  v_mfma_f32_16x16x32_bf16 v[16:19], v[28:31], v[56:59], v[16:19]
  v_mfma_f32_16x16x32_bf16 v[20:23], v[28:31], v[60:63], v[20:23]
  buffer_load_dwordx4 v[56:59], v4, s[48:51], s67 offen offset:2048 nt
  buffer_load_dwordx4 v[60:63], v4, s[48:51], s67 offen offset:2304 nt
  s_cmp_eq_u32 s46, 0
  s_cbranch_scc1 L_sdone
L_v1:
  s_waitcnt lgkmcnt(0)
  v_readfirstlane_b32 s30, v248
  v_readfirstlane_b32 s31, v249
  v_cmp_ne_u16 vcc, 0, v226
  s_cbranch_vccnz L_rt1
  s_lshr_b32 s70, s31, 16
  s_and_b32 s31, s31, 0xffff
  s_cmp_lt_u32 s30, s70
  s_cselect_b32 s68, 1, 0
  s_add_u32 s70, s70, 3
  s_cmp_lt_u32 s30, s70
  s_addc_u32 s68, s68, 0
  s_add_u32 s69, s30, 10
  s_cmp_ge_u32 s69, s31
  s_cselect_b32 s68, 3, s68
  s_cmp_lt_u32 s30, s31
  s_cbranch_scc0 L_finv1
  s_bfe_u32 s64, s30, 0x10000
  s_lshl_b32 s64, s64, 12
  s_xor_b32 s44, s64, s65
  s_bfe_u32 s64, s30, 0x10001
  s_lshl_b32 s64, s64, 16
  s_xor_b32 s44, s64, s44
  s_bfe_u32 s64, s30, 0x10002
  s_lshl_b32 s64, s64, 15
  s_xor_b32 s44, s64, s44
  s_bfe_u32 s64, s30, 0x40003
  s_lshl_b32 s64, s64, 17
  s_xor_b32 s44, s64, s44
  s_add_u32 s67, s44, 8192
  s_lshl_b32 s78, s30, 6
  s_add_u32 s78, s78, 139264
  s_mov_b64 exec, 1
  ds_add_rtn_u64 v[248:249], v251, v[250:251] offset:560
  s_mov_b64 exec, -1
L_gov1:
  v_max_f32_dpp v227, v226, v226 row_ror:8
  s_nop 1
  v_max_f32_dpp v227, v227, v227 row_ror:4
  v_max_f32 v227, s61, v227
  s_nop 1
  v_max_f32_dpp v227, v227, v227 row_bcast:15 row_mask:0xa
  s_nop 1
  v_max_f32_dpp v227, v227, v227 row_bcast:31 row_mask:0xc
  s_nop 0
  v_readlane_b32 s61, v227, 63
  v_and_or_b32 v227, v0, 60, s77
  s_nop 0
  v_mul_f32 v229, s61, v235
  v_sub_f32 v230, v229, v228
  v_fma_f32 v231, v226, v234, v229
  ds_read_b32 v226, v227
  v_exp_f32 v230, v230
  v_exp_f32 v231, v231
  v_mul_f32 v16, v230, v16
  v_cvt_pk_bf16_f32 v232, v231, v231
  v_mul_f32 v17, v230, v17
  v_mul_f32 v20, v230, v20
  v_and_b32_dpp v8, v232, v1 row_newbcast:0 bank_mask:0x1
  v_and_b32_dpp v9, v232, v1 row_newbcast:0 bank_mask:0x2
  v_and_b32_dpp v10, v232, v1 row_newbcast:0 bank_mask:0x4
  v_and_b32_dpp v11, v232, v1 row_newbcast:0 bank_mask:0x8
  v_mul_f32 v21, v230, v21
  v_fma_f32 v233, v233, v230, v231
  v_and_b32_dpp v12, v232, v1 row_newbcast:8 bank_mask:0x1
  v_and_b32_dpp v13, v232, v1 row_newbcast:8 bank_mask:0x2
  v_and_b32_dpp v14, v232, v1 row_newbcast:8 bank_mask:0x4
  v_and_b32_dpp v15, v232, v1 row_newbcast:8 bank_mask:0x8
  v_and_b32_dpp v24, v232, v1 row_newbcast:4 bank_mask:0x1
  v_and_b32_dpp v25, v232, v1 row_newbcast:4 bank_mask:0x2
  v_and_b32_dpp v26, v232, v1 row_newbcast:4 bank_mask:0x4
  v_and_b32_dpp v27, v232, v1 row_newbcast:4 bank_mask:0x8
  v_and_b32_dpp v28, v232, v1 row_newbcast:12 bank_mask:0x1
  v_and_b32_dpp v29, v232, v1 row_newbcast:12 bank_mask:0x2
  v_and_b32_dpp v30, v232, v1 row_newbcast:12 bank_mask:0x4
  v_and_b32_dpp v31, v232, v1 row_newbcast:12 bank_mask:0x8
  s_cmp_ge_u32 s68, 3
  s_cbranch_scc1 L_tv10_3
  s_cmp_ge_u32 s68, 2
  s_cbranch_scc1 L_tv10_2
  s_cmp_ge_u32 s68, 1
  s_cbranch_scc1 L_tv10_1
  s_waitcnt vmcnt(0)
L_tv10_1:
  s_waitcnt vmcnt(2)
L_tv10_2:
  s_waitcnt vmcnt(4)
L_tv10_3:
  s_waitcnt vmcnt(14)
  v_mfma_f32_16x16x32_bf16 v[16:19], v[8:11], v[64:67], v[16:19]
  v_mfma_f32_16x16x32_bf16 v[20:23], v[8:11], v[68:71], v[20:23]
  buffer_load_dwordx4 v[64:67], v4, s[48:51], s44 offen offset:0 nt
  buffer_load_dwordx4 v[68:71], v4, s[48:51], s44 offen offset:256 nt
  s_waitcnt vmcnt(14)
  v_mfma_f32_16x16x32_bf16 v[16:19], v[12:15], v[72:75], v[16:19]
  v_mfma_f32_16x16x32_bf16 v[20:23], v[12:15], v[76:79], v[20:23]
  buffer_load_dwordx4 v[72:75], v4, s[48:51], s67 offen offset:0 nt
  buffer_load_dwordx4 v[76:79], v4, s[48:51], s67 offen offset:256 nt
  s_cmp_ge_u32 s68, 3
  s_cbranch_scc1 L_tv12_3
  s_cmp_ge_u32 s68, 2
  s_cbranch_scc1 L_tv12_2
  s_cmp_ge_u32 s68, 1
  s_cbranch_scc1 L_tv12_1
  s_waitcnt vmcnt(0)
L_tv12_1:
  s_waitcnt vmcnt(2)
L_tv12_2:
  s_waitcnt vmcnt(4)
L_tv12_3:
  s_waitcnt vmcnt(14)
  v_mfma_f32_16x16x32_bf16 v[16:19], v[24:27], v[80:83], v[16:19]
  v_mfma_f32_16x16x32_bf16 v[20:23], v[24:27], v[84:87], v[20:23]
  buffer_load_dwordx4 v[80:83], v4, s[48:51], s44 offen offset:2048 nt
  buffer_load_dwordx4 v[84:87], v4, s[48:51], s44 offen offset:2304 nt
  s_waitcnt vmcnt(14)
  v_mfma_f32_16x16x32_bf16 v[16:19], v[28:31], v[88:91], v[16:19]
  v_mfma_f32_16x16x32_bf16 v[20:23], v[28:31], v[92:95], v[20:23]
  buffer_load_dwordx4 v[88:91], v4, s[48:51], s67 offen offset:2048 nt
  buffer_load_dwordx4 v[92:95], v4, s[48:51], s67 offen offset:2304 nt
  s_cmp_eq_u32 s46, 0
  s_cbranch_scc1 L_sdone
  s_branch L_v0
L_fink0:
  s_mov_b32 s44, s45
  s_mov_b32 s67, s45
  s_mov_b32 s68, 3
  s_sub_u32 s46, s46, 1
  s_branch L_gok0
L_finv0:
  s_mov_b32 s44, s45
  s_mov_b32 s67, s45
  s_mov_b32 s68, 3
  s_sub_u32 s46, s46, 1
  s_branch L_gov0
L_tr0:
  v_mov_b64 v[24:25], 0
  v_mov_b64 v[26:27], 0
  v_mov_b64 v[28:29], 0
  v_mov_b64 v[30:31], 0
L_rt0:
  v_and_or_b32 v227, v0, 60, s77
  ds_read_b32 v226, v227
  s_branch L_v0
L_fink1:
  s_mov_b32 s44, s45
  s_mov_b32 s67, s45
  s_mov_b32 s68, 3
  s_sub_u32 s46, s46, 1
  s_branch L_gok1
L_finv1:
  s_mov_b32 s44, s45
  s_mov_b32 s67, s45
  s_mov_b32 s68, 3
  s_sub_u32 s46, s46, 1
  s_branch L_gov1
L_tr1:
  v_mov_b64 v[24:25], 0
  v_mov_b64 v[26:27], 0
  v_mov_b64 v[28:29], 0
  v_mov_b64 v[30:31], 0
L_rt1:
  v_and_or_b32 v227, v0, 60, s78
  ds_read_b32 v226, v227
  s_branch L_v1
L_wld:
  s_cmp_eq_u32 s71, 184
  s_cbranch_scc1 L_wld1
  s_cmp_eq_u32 s71, 188
  s_cbranch_scc1 L_wld2
  s_cmp_eq_u32 s71, 192
  s_cbranch_scc1 L_wld3
  s_cmp_eq_u32 s71, 196
  s_cbranch_scc1 L_wld4
  s_cmp_eq_u32 s71, 200
  s_cbranch_scc1 L_wld5
  s_cmp_eq_u32 s71, 204
  s_cbranch_scc1 L_wld6
  s_cmp_eq_u32 s71, 208
  s_cbranch_scc1 L_wld7
L_wld0:
  ds_read_b32 v224, v251 offset:548
  s_waitcnt lgkmcnt(0)
  v_readfirstlane_b32 s71, v224
  s_cmp_lt_u32 s71, 2
  s_cbranch_scc1 L_wld0
  s_lshl_b32 s71, s38, 15
  s_add_u32 s71, s71, 16384
  v_bfe_u32 v227, v0, 2, 2
  v_lshlrev_b32 v227, 7, v227
  v_lshrrev_b32 v225, 4, v0
  v_lshl_add_u32 v227, v225, 10, v227
  v_and_b32 v225, 3, v0
  v_lshl_add_u32 v225, v225, 3, v227
  v_add_u32 v225, s71, v225
  ds_read_b64_tr_b16 v[96:97], v225 offset:0
  ds_read_b64_tr_b16 v[98:99], v225 offset:512
  ds_read_b64_tr_b16 v[104:105], v225 offset:32
  ds_read_b64_tr_b16 v[106:107], v225 offset:544
  ds_read_b64_tr_b16 v[112:113], v225 offset:64
  ds_read_b64_tr_b16 v[114:115], v225 offset:576
  ds_read_b64_tr_b16 v[120:121], v225 offset:96
  ds_read_b64_tr_b16 v[122:123], v225 offset:608
  s_movk_i32 s71, 184
  s_branch L_wldx
L_wld1:
  s_lshl_b32 s71, s38, 15
  s_add_u32 s71, s71, 16384
  v_bfe_u32 v227, v0, 2, 2
  v_lshlrev_b32 v227, 7, v227
  v_lshrrev_b32 v225, 4, v0
  v_lshl_add_u32 v227, v225, 10, v227
  v_and_b32 v225, 3, v0
  v_lshl_add_u32 v225, v225, 3, v227
  v_add_u32 v225, s71, v225
  ds_read_b64_tr_b16 v[100:101], v225 offset:4096
  ds_read_b64_tr_b16 v[102:103], v225 offset:4608
  ds_read_b64_tr_b16 v[108:109], v225 offset:4128
  ds_read_b64_tr_b16 v[110:111], v225 offset:4640
  ds_read_b64_tr_b16 v[116:117], v225 offset:4160
  ds_read_b64_tr_b16 v[118:119], v225 offset:4672
  ds_read_b64_tr_b16 v[124:125], v225 offset:4192
  ds_read_b64_tr_b16 v[126:127], v225 offset:4704
  s_movk_i32 s71, 188
  s_branch L_wldx
L_wld2:
  s_lshl_b32 s71, s38, 15
  s_add_u32 s71, s71, 16384
  v_bfe_u32 v227, v0, 2, 2
  v_lshlrev_b32 v227, 7, v227
  v_lshrrev_b32 v225, 4, v0
  v_lshl_add_u32 v227, v225, 10, v227
  v_and_b32 v225, 3, v0
  v_lshl_add_u32 v225, v225, 3, v227
  v_add_u32 v225, s71, v225
  ds_read_b64_tr_b16 v[128:129], v225 offset:8192
  ds_read_b64_tr_b16 v[130:131], v225 offset:8704
  ds_read_b64_tr_b16 v[136:137], v225 offset:8224
  ds_read_b64_tr_b16 v[138:139], v225 offset:8736
  ds_read_b64_tr_b16 v[144:145], v225 offset:8256
  ds_read_b64_tr_b16 v[146:147], v225 offset:8768
  ds_read_b64_tr_b16 v[152:153], v225 offset:8288
  ds_read_b64_tr_b16 v[154:155], v225 offset:8800
  s_movk_i32 s71, 192
  s_branch L_wldx
L_wld3:
  s_lshl_b32 s71, s38, 15
  s_add_u32 s71, s71, 16384
  v_bfe_u32 v227, v0, 2, 2
  v_lshlrev_b32 v227, 7, v227
  v_lshrrev_b32 v225, 4, v0
  v_lshl_add_u32 v227, v225, 10, v227
  v_and_b32 v225, 3, v0
  v_lshl_add_u32 v225, v225, 3, v227
  v_add_u32 v225, s71, v225
  ds_read_b64_tr_b16 v[132:133], v225 offset:12288
  ds_read_b64_tr_b16 v[134:135], v225 offset:12800
  ds_read_b64_tr_b16 v[140:141], v225 offset:12320
  ds_read_b64_tr_b16 v[142:143], v225 offset:12832
  ds_read_b64_tr_b16 v[148:149], v225 offset:12352
  ds_read_b64_tr_b16 v[150:151], v225 offset:12864
  ds_read_b64_tr_b16 v[156:157], v225 offset:12384
  ds_read_b64_tr_b16 v[158:159], v225 offset:12896
  s_movk_i32 s71, 196
  s_branch L_wldx
L_wld4:
  s_lshl_b32 s71, s38, 15
  s_add_u32 s71, s71, 16384
  v_bfe_u32 v227, v0, 2, 2
  v_lshlrev_b32 v227, 7, v227
  v_lshrrev_b32 v225, 4, v0
  v_lshl_add_u32 v227, v225, 10, v227
  v_and_b32 v225, 3, v0
  v_lshl_add_u32 v225, v225, 3, v227
  v_add_u32 v225, s71, v225
  ds_read_b64_tr_b16 v[160:161], v225 offset:16384
  ds_read_b64_tr_b16 v[162:163], v225 offset:16896
  ds_read_b64_tr_b16 v[168:169], v225 offset:16416
  ds_read_b64_tr_b16 v[170:171], v225 offset:16928
  ds_read_b64_tr_b16 v[176:177], v225 offset:16448
  ds_read_b64_tr_b16 v[178:179], v225 offset:16960
  ds_read_b64_tr_b16 v[184:185], v225 offset:16480
  ds_read_b64_tr_b16 v[186:187], v225 offset:16992
  s_movk_i32 s71, 200
  s_branch L_wldx
L_wld5:
  s_lshl_b32 s71, s38, 15
  s_add_u32 s71, s71, 16384
  v_bfe_u32 v227, v0, 2, 2
  v_lshlrev_b32 v227, 7, v227
  v_lshrrev_b32 v225, 4, v0
  v_lshl_add_u32 v227, v225, 10, v227
  v_and_b32 v225, 3, v0
  v_lshl_add_u32 v225, v225, 3, v227
  v_add_u32 v225, s71, v225
  ds_read_b64_tr_b16 v[164:165], v225 offset:20480
  ds_read_b64_tr_b16 v[166:167], v225 offset:20992
  ds_read_b64_tr_b16 v[172:173], v225 offset:20512
  ds_read_b64_tr_b16 v[174:175], v225 offset:21024
  ds_read_b64_tr_b16 v[180:181], v225 offset:20544
  ds_read_b64_tr_b16 v[182:183], v225 offset:21056
  ds_read_b64_tr_b16 v[188:189], v225 offset:20576
  ds_read_b64_tr_b16 v[190:191], v225 offset:21088
  s_movk_i32 s71, 204
  s_branch L_wldx
L_wld6:
  s_lshl_b32 s71, s38, 15
  s_add_u32 s71, s71, 16384
  v_bfe_u32 v227, v0, 2, 2
  v_lshlrev_b32 v227, 7, v227
  v_lshrrev_b32 v225, 4, v0
  v_lshl_add_u32 v227, v225, 10, v227
  v_and_b32 v225, 3, v0
  v_lshl_add_u32 v225, v225, 3, v227
  v_add_u32 v225, s71, v225
  ds_read_b64_tr_b16 v[192:193], v225 offset:24576
  ds_read_b64_tr_b16 v[194:195], v225 offset:25088
  ds_read_b64_tr_b16 v[200:201], v225 offset:24608
  ds_read_b64_tr_b16 v[202:203], v225 offset:25120
  ds_read_b64_tr_b16 v[208:209], v225 offset:24640
  ds_read_b64_tr_b16 v[210:211], v225 offset:25152
  ds_read_b64_tr_b16 v[216:217], v225 offset:24672
  ds_read_b64_tr_b16 v[218:219], v225 offset:25184
  s_movk_i32 s71, 208
  s_branch L_wldx
L_wld7:
  s_lshl_b32 s71, s38, 15
  s_add_u32 s71, s71, 16384
  v_bfe_u32 v227, v0, 2, 2
  v_lshlrev_b32 v227, 7, v227
  v_lshrrev_b32 v225, 4, v0
  v_lshl_add_u32 v227, v225, 10, v227
  v_and_b32 v225, 3, v0
  v_lshl_add_u32 v225, v225, 3, v227
  v_add_u32 v225, s71, v225
  ds_read_b64_tr_b16 v[196:197], v225 offset:28672
  ds_read_b64_tr_b16 v[198:199], v225 offset:29184
  ds_read_b64_tr_b16 v[204:205], v225 offset:28704
  ds_read_b64_tr_b16 v[206:207], v225 offset:29216
  ds_read_b64_tr_b16 v[212:213], v225 offset:28736
  ds_read_b64_tr_b16 v[214:215], v225 offset:29248
  ds_read_b64_tr_b16 v[220:221], v225 offset:28768
  ds_read_b64_tr_b16 v[222:223], v225 offset:29280
  s_mov_b32 s71, -1
  s_branch L_wldx
L_wfix:
  ds_read_b32 v224, v251 offset:548
  s_waitcnt lgkmcnt(0)
  v_readfirstlane_b32 s71, v224
  s_cmp_lt_u32 s71, 2
  s_cbranch_scc1 L_wfix
  s_lshl_b32 s71, s38, 15
  s_add_u32 s71, s71, 16384
  v_bfe_u32 v227, v0, 2, 2
  v_lshlrev_b32 v227, 7, v227
  v_lshrrev_b32 v225, 4, v0
  v_lshl_add_u32 v227, v225, 10, v227
  v_and_b32 v225, 3, v0
  v_lshl_add_u32 v225, v225, 3, v227
  v_add_u32 v225, s71, v225
  ds_read_b64_tr_b16 v[96:97], v225 offset:0
  ds_read_b64_tr_b16 v[98:99], v225 offset:512
  ds_read_b64_tr_b16 v[104:105], v225 offset:32
  ds_read_b64_tr_b16 v[106:107], v225 offset:544
  ds_read_b64_tr_b16 v[112:113], v225 offset:64
  ds_read_b64_tr_b16 v[114:115], v225 offset:576
  ds_read_b64_tr_b16 v[120:121], v225 offset:96
  ds_read_b64_tr_b16 v[122:123], v225 offset:608
  ds_read_b64_tr_b16 v[100:101], v225 offset:4096
  ds_read_b64_tr_b16 v[102:103], v225 offset:4608
  ds_read_b64_tr_b16 v[108:109], v225 offset:4128
  ds_read_b64_tr_b16 v[110:111], v225 offset:4640
  ds_read_b64_tr_b16 v[116:117], v225 offset:4160
  ds_read_b64_tr_b16 v[118:119], v225 offset:4672
  ds_read_b64_tr_b16 v[124:125], v225 offset:4192
  ds_read_b64_tr_b16 v[126:127], v225 offset:4704
  ds_read_b64_tr_b16 v[128:129], v225 offset:8192
  ds_read_b64_tr_b16 v[130:131], v225 offset:8704
  ds_read_b64_tr_b16 v[136:137], v225 offset:8224
  ds_read_b64_tr_b16 v[138:139], v225 offset:8736
  ds_read_b64_tr_b16 v[144:145], v225 offset:8256
  ds_read_b64_tr_b16 v[146:147], v225 offset:8768
  ds_read_b64_tr_b16 v[152:153], v225 offset:8288
  ds_read_b64_tr_b16 v[154:155], v225 offset:8800
  ds_read_b64_tr_b16 v[132:133], v225 offset:12288
  ds_read_b64_tr_b16 v[134:135], v225 offset:12800
  ds_read_b64_tr_b16 v[140:141], v225 offset:12320
  ds_read_b64_tr_b16 v[142:143], v225 offset:12832
  ds_read_b64_tr_b16 v[148:149], v225 offset:12352
  ds_read_b64_tr_b16 v[150:151], v225 offset:12864
  ds_read_b64_tr_b16 v[156:157], v225 offset:12384
  ds_read_b64_tr_b16 v[158:159], v225 offset:12896
  ds_read_b64_tr_b16 v[160:161], v225 offset:16384
  ds_read_b64_tr_b16 v[162:163], v225 offset:16896
  ds_read_b64_tr_b16 v[168:169], v225 offset:16416
  ds_read_b64_tr_b16 v[170:171], v225 offset:16928
  ds_read_b64_tr_b16 v[176:177], v225 offset:16448
  ds_read_b64_tr_b16 v[178:179], v225 offset:16960
  ds_read_b64_tr_b16 v[184:185], v225 offset:16480
  ds_read_b64_tr_b16 v[186:187], v225 offset:16992
  ds_read_b64_tr_b16 v[164:165], v225 offset:20480
  ds_read_b64_tr_b16 v[166:167], v225 offset:20992
  ds_read_b64_tr_b16 v[172:173], v225 offset:20512
  ds_read_b64_tr_b16 v[174:175], v225 offset:21024
  ds_read_b64_tr_b16 v[180:181], v225 offset:20544
  ds_read_b64_tr_b16 v[182:183], v225 offset:21056
  ds_read_b64_tr_b16 v[188:189], v225 offset:20576
  ds_read_b64_tr_b16 v[190:191], v225 offset:21088
  ds_read_b64_tr_b16 v[192:193], v225 offset:24576
  ds_read_b64_tr_b16 v[194:195], v225 offset:25088
  ds_read_b64_tr_b16 v[200:201], v225 offset:24608
  ds_read_b64_tr_b16 v[202:203], v225 offset:25120
  ds_read_b64_tr_b16 v[208:209], v225 offset:24640
  ds_read_b64_tr_b16 v[210:211], v225 offset:25152
  ds_read_b64_tr_b16 v[216:217], v225 offset:24672
  ds_read_b64_tr_b16 v[218:219], v225 offset:25184
  ds_read_b64_tr_b16 v[196:197], v225 offset:28672
  ds_read_b64_tr_b16 v[198:199], v225 offset:29184
  ds_read_b64_tr_b16 v[204:205], v225 offset:28704
  ds_read_b64_tr_b16 v[206:207], v225 offset:29216
  ds_read_b64_tr_b16 v[212:213], v225 offset:28736
  ds_read_b64_tr_b16 v[214:215], v225 offset:29248
  ds_read_b64_tr_b16 v[220:221], v225 offset:28768
  ds_read_b64_tr_b16 v[222:223], v225 offset:29280
  s_mov_b32 s71, -1
  s_waitcnt lgkmcnt(0)
L_sdone:
  s_cmp_lg_u32 s71, -1
  s_cbranch_scc1 L_wfix
  s_waitcnt lgkmcnt(0)
  v_add_f32_dpp v233, v233, v233 row_ror:8
  v_mov_b32 v226, s61
  s_nop 0
  v_add_f32_dpp v233, v233, v233 row_ror:4
  s_nop 1
  v_add_f32_dpp v233, v233, v233 row_bcast:15 row_mask:0xa
  v_cvt_pk_bf16_f32 v16, v16, v17
  v_cvt_pk_bf16_f32 v20, v20, v21
  v_add_f32_dpp v227, v233, v233 row_bcast:31 row_mask:0xc
  ds_write2_b32 v6, v16, v20 offset0:0 offset1:32
  s_lshl_b64 exec, exec, 63
  ds_write_b64 v2, v[226:227] offset:512
  s_mov_b64 exec, -1
  s_waitcnt lgkmcnt(0)
L_tail:
  s_barrier
  ds_read_b128 v[8:11], v3 offset:1024
  ds_read_b128 v[12:15], v3 offset:1088
  ds_read_b128 v[24:27], v255 offset:512
  ds_read_b128 v[28:31], v255 offset:528
  ds_read_b128 v[16:19], v3 offset:1152
  ds_read_b128 v[20:23], v3 offset:1216
  v_mov_b32 v6, s60
  s_movk_i32 s73, 0xfff
  s_waitcnt lgkmcnt(5)
  v_smfmac_f32_16x16x64_bf16 v[236:239], v[8:11], v[96:103], v5
  v_smfmac_f32_16x16x64_bf16 v[240:243], v[8:11], v[104:111], v5
  v_smfmac_f32_16x16x64_bf16 v[244:247], v[8:11], v[112:119], v5
  v_smfmac_f32_16x16x64_bf16 v[252:255], v[8:11], v[120:127], v5
  s_waitcnt lgkmcnt(4)
  v_smfmac_f32_16x16x64_bf16 v[236:239], v[12:15], v[128:135], v5
  v_smfmac_f32_16x16x64_bf16 v[240:243], v[12:15], v[136:143], v5
  v_smfmac_f32_16x16x64_bf16 v[244:247], v[12:15], v[144:151], v5
  v_smfmac_f32_16x16x64_bf16 v[252:255], v[12:15], v[152:159], v5
  s_waitcnt lgkmcnt(1)
  v_smfmac_f32_16x16x64_bf16 v[236:239], v[16:19], v[160:167], v5
  v_max3_f32 v1, v24, v26, v28
  v_max_f32 v1, v1, v30
  v_smfmac_f32_16x16x64_bf16 v[240:243], v[16:19], v[168:175], v5
  v_mul_f32 v2, 0xbdb8aa3b, v1
  v_fmamk_f32 v24, v24, 0x3db8aa3b, v2
  v_smfmac_f32_16x16x64_bf16 v[244:247], v[16:19], v[176:183], v5
  v_fmamk_f32 v26, v26, 0x3db8aa3b, v2
  v_fmamk_f32 v28, v28, 0x3db8aa3b, v2
  v_smfmac_f32_16x16x64_bf16 v[252:255], v[16:19], v[184:191], v5
  v_fmamk_f32 v30, v30, 0x3db8aa3b, v2
  v_exp_f32 v24, v24
  s_waitcnt lgkmcnt(0)
  v_smfmac_f32_16x16x64_bf16 v[236:239], v[20:23], v[192:199], v5
  v_exp_f32 v26, v26
  v_smfmac_f32_16x16x64_bf16 v[244:247], v[20:23], v[208:215], v5
  v_exp_f32 v28, v28
  v_smfmac_f32_16x16x64_bf16 v[240:243], v[20:23], v[200:207], v5
  v_exp_f32 v30, v30
  v_smfmac_f32_16x16x64_bf16 v[252:255], v[20:23], v[216:223], v5
  s_nop 1
  v_mul_f32_dpp v1, v236, v24 quad_perm:[0,1,2,3] row_mask:0x3
  v_fmac_f32_dpp v1, v237, v26 quad_perm:[0,1,2,3] row_mask:0x3
  v_fmac_f32_dpp v1, v238, v28 quad_perm:[0,1,2,3] row_mask:0x3
  v_fmac_f32_dpp v1, v239, v30 quad_perm:[0,1,2,3] row_mask:0x3
  v_mul_f32_dpp v1, v244, v24 quad_perm:[0,1,2,3] row_mask:0xc
  v_fmac_f32_dpp v1, v245, v26 quad_perm:[0,1,2,3] row_mask:0xc
  v_fmac_f32_dpp v1, v246, v28 quad_perm:[0,1,2,3] row_mask:0xc
  v_fmac_f32_dpp v1, v247, v30 quad_perm:[0,1,2,3] row_mask:0xc
  v_mul_f32_dpp v2, v240, v24 quad_perm:[0,1,2,3] row_mask:0x3
  v_fmac_f32_dpp v2, v241, v26 quad_perm:[0,1,2,3] row_mask:0x3
  v_fmac_f32_dpp v2, v242, v28 quad_perm:[0,1,2,3] row_mask:0x3
  v_fmac_f32_dpp v2, v243, v30 quad_perm:[0,1,2,3] row_mask:0x3
  v_mul_f32_dpp v2, v252, v24 quad_perm:[0,1,2,3] row_mask:0xc
  v_fmac_f32_dpp v2, v253, v26 quad_perm:[0,1,2,3] row_mask:0xc
  v_fmac_f32_dpp v2, v254, v28 quad_perm:[0,1,2,3] row_mask:0xc
  v_fmac_f32_dpp v2, v255, v30 quad_perm:[0,1,2,3] row_mask:0xc
  s_nop 1
  v_permlane16_swap_b32 v1, v2
  v_add_f32 v1, v1, v2
  v_bfi_b32 v1, s73, v6, v1
  buffer_store_dword v1, v7, s[40:43], s72 offen sc1
  s_endpgm
L_end:
  s_endpgm
.section .rodata,"a"
.p2align 6
.amdhsa_kernel gated_mix__mha_block_cached__swiglu_ffn__decode_kernel
  .amdhsa_next_free_vgpr 256
  .amdhsa_next_free_sgpr 102
  .amdhsa_accum_offset 256
  .amdhsa_group_segment_fixed_size 0
  .amdhsa_kernarg_size 104
  .amdhsa_user_sgpr_count 2
  .amdhsa_user_sgpr_kernarg_segment_ptr 1
  .amdhsa_system_sgpr_workgroup_id_x 1
.end_amdhsa_kernel
```
